```python
import torch

def _softmax(x, axis=-1):
    return torch.softmax(x, dim=axis)
def _gelu(x):
    return torch.nn.functional.gelu(x, approximate="tanh")
def _silu(x):
    return torch.nn.functional.silu(x)
def _sigmoid(x):
    return torch.sigmoid(x)
def _layernorm(x, axis=-1, eps=1e-5):
    m = x.mean(dim=axis, keepdim=True)
    v = x.var(dim=axis, keepdim=True, unbiased=False)
    return (x - m) / torch.sqrt(v + eps)
def _scatter_add(tgt, idx, src, axis=0):
    return tgt.clone().index_add_(axis, idx, src)
def _segment_sum(src, seg, n):
    out = torch.zeros((n,) + src.shape[1:], dtype=src.dtype)
    return out.index_add_(0, seg, src)
def _pad(x, pw):
    flat = tuple(v for pair in reversed(pw) for v in pair)
    return torch.nn.functional.pad(x, flat)

kernel_name = 'sequential_preLN__sliding_block_cached__swiglu_ffn__decode'

def setup_inputs():

    _w = (lambda a: (lambda t: t.to(torch.bfloat16) if t.is_floating_point() else t)(torch.as_tensor(a)))
    def _A_setup():
        B, Sq, D = 4, 1, 512
        Hq, Hkv, Sk, Dh = 32, 8, 16384, 128
        assert Hq % Hkv == 0, (Hq, Hkv)
        return {
            "x": _w((lambda *s: torch.randn(*s, dtype=torch.bfloat16) * 0.05)(B, Sq, D)),
            "k_cache": _w((lambda *s: torch.randn(*s, dtype=torch.bfloat16) * 3.2)(B, Hkv, Sk, Dh)),
            "v_cache": _w((lambda *s: torch.randn(*s, dtype=torch.bfloat16) * 0.4)(B, Hkv, Sk, Dh)),
            "wq": _w((lambda *s: torch.randn(*s, dtype=torch.bfloat16) * 3.2)(D, Hq * Dh) * (D ** -0.5)),
            "wo": _w((lambda *s: torch.randn(*s, dtype=torch.bfloat16) * 0.4)(Hq * Dh, D) * ((Hq * Dh) ** -0.5)),
        }
    _A_in = _A_setup()

    def _B_setup():
        B, S, D, F = 4, 1, 512, 1792
        return {
            "x": _w((lambda *s: torch.randn(*s, dtype=torch.bfloat16) * 0.05)(B, S, D)),
            "w_gate": _w((lambda *s: torch.randn(*s, dtype=torch.bfloat16) * 0.05)(D, F)),
            "w_up": _w((lambda *s: torch.randn(*s, dtype=torch.bfloat16) * 0.05)(D, F)),
            "w_down": _w((lambda *s: torch.randn(*s, dtype=torch.bfloat16) * 0.05)(F, D)),
        }
    _B_in = _B_setup()

    return {
        "A_x": _A_in["x"],
        "A_k_cache": _A_in["k_cache"],
        "A_v_cache": _A_in["v_cache"],
        "A_wq": _A_in["wq"],
        "A_wo": _A_in["wo"],
        "B_x": _B_in["x"],
        "B_w_gate": _B_in["w_gate"],
        "B_w_up": _B_in["w_up"],
        "B_w_down": _B_in["w_down"],
    }

def reference(A_x, A_k_cache, A_v_cache, A_wq, A_wo, B_x, B_w_gate, B_w_up, B_w_down):
    def _A_ref(x, k_cache, v_cache, wq, wo):
        B, Sq, D = x.shape
        Hq, Dh = 32, 128
        Hkv, Sk = k_cache.shape[1], k_cache.shape[2]
        W = min(4096, max(256, Sk // 4))
        rep = Hq // Hkv
        q = (lambda x, *d: x.permute(*d))((x @ wq).reshape(B, Sq, Hq, Dh), 0, 2, 1, 3)
        k = (lambda x, n, axis: torch.repeat_interleave(x, n, dim=axis))(k_cache[:, :, Sk - W:, :], rep, axis=1)
        v = (lambda x, n, axis: torch.repeat_interleave(x, n, dim=axis))(v_cache[:, :, Sk - W:, :], rep, axis=1)
        scores = torch.einsum("bhqd,bhkd->bhqk", q, k) * (Dh ** -0.5)
        p = _softmax(scores, axis=-1)
        o = torch.einsum("bhqk,bhkd->bhqd", p, v)
        return (lambda x, *d: x.permute(*d))(o, 0, 2, 1, 3).reshape(B, Sq, Hq * Dh) @ wo

    def _B_ref(x, w_gate, w_up, w_down):
        g = _silu(x @ w_gate)
        u = x @ w_up
        return (g * u) @ w_down

    x = A_x
    h = x + _A_ref(_layernorm(x, axis=-1), A_k_cache, A_v_cache, A_wq, A_wo)
    h2 = h + _B_ref(_layernorm(h, axis=-1), B_w_gate, B_w_up, B_w_down)
    return h2
```

```asm
; @launch grid=(256,1,1) block=(512,1,1) lds=149504
.amdgcn_target "amdgcn-amd-amdhsa--gfx950"
.text
.globl sequential_preLN__sliding_block_cached__swiglu_ffn__decode_kernel
.p2align 8
.type sequential_preLN__sliding_block_cached__swiglu_ffn__decode_kernel,@function
sequential_preLN__sliding_block_cached__swiglu_ffn__decode_kernel:
    s_load_dwordx16 s[4:19], s[0:1], 0
    s_load_dwordx8 s[20:27], s[0:1], 64
    s_cmp_ge_u32 s2, 256
    s_cbranch_scc1 L_end
    v_readfirstlane_b32 s3, v0
    v_and_b32 v0, 63, v0
    v_lshrrev_b32 v12, 4, v0
    v_and_b32 v13, 15, v0
    s_and_b32 s28, s2, 7
    s_lshr_b32 s30, s2, 5
    s_and_b32 s60, s2, 31
    s_lshl_b32 s60, s60, 7
    s_add_u32 s60, s60, s30
    s_add_u32 s60, s60, 96
    s_lshl_b32 s60, s60, 15
    s_lshr_b32 s3, s3, 6
    s_cbranch_scc1 L_rest
    v_lshlrev_b32 v1, 2, v12
    v_xor_b32 v1, v1, v13
    v_lshlrev_b32 v1, 4, v1
    v_lshl_add_u32 v4, v12, 8, v1
    v_xor_b32 v5, 16, v4
    v_xor_b32 v6, 32, v4
    v_xor_b32 v7, 48, v4
    s_mov_b32 s48, 0
    s_mov_b32 s42, 0x8000000
    s_mov_b32 s43, 0x20000
    s_waitcnt lgkmcnt(0)
    s_mov_b64 s[40:41], s[6:7]
L_kA:
    s_add_u32 s49, s48, s28
    s_and_b32 s49, s49, 7
    s_lshl_b32 s49, s49, 12
    s_add_u32 s49, s49, s60
    s_lshl_b32 m0, s48, 12
    s_add_u32 s48, s48, 1
    buffer_load_dwordx4 v4, s[40:43], s49 offen offset:0 nt lds
    buffer_load_dwordx4 v5, s[40:43], s49 offen offset:1024 nt lds
    buffer_load_dwordx4 v6, s[40:43], s49 offen offset:2048 nt lds
    buffer_load_dwordx4 v7, s[40:43], s49 offen offset:3072 nt lds
    s_cmp_lt_u32 s48, 7
    s_cbranch_scc1 L_kA
    s_bfe_u32 s29, s2, 0x20003
    s_mov_b32 s32, 0x80000
    s_mov_b32 s34, 0x05040100
    s_mov_b32 s35, 0x07060302
    v_mov_b32 v14, 148992
    s_lshl_b32 s63, s28, 1
    s_lshr_b32 s61, s29, 1
    s_add_u32 s63, s63, s61
    s_mul_i32 s63, s63, 278528
    s_and_b32 s101, s29, 1
    s_mov_b32 s31, 3
    s_barrier
L_kB:
    s_waitcnt vmcnt(20)
    s_sub_u32 s51, s48, 5
    s_max_i32 s51, s51, 0
    v_mov_b32 v15, s51
    ds_write_b32 v14, v15 offset:4
    s_add_u32 s49, s48, s28
    s_and_b32 s49, s49, 7
    s_lshl_b32 s49, s49, 12
    s_lshr_b32 s50, s48, 3
    s_lshl_b32 s50, s50, 18
    s_add_u32 s49, s49, s50
    s_add_u32 s49, s49, s60
    s_lshl_b32 m0, s48, 12
    s_add_u32 s48, s48, 1
    buffer_load_dwordx4 v4, s[40:43], s49 offen offset:0 nt lds
    buffer_load_dwordx4 v5, s[40:43], s49 offen offset:1024 nt lds
    buffer_load_dwordx4 v6, s[40:43], s49 offen offset:2048 nt lds
    buffer_load_dwordx4 v7, s[40:43], s49 offen offset:3072 nt lds
    s_cmp_lt_u32 s48, 32
    s_cbranch_scc1 L_kB
    v_mov_b32 v15, 1
    ds_write_b32 v14, v15 offset:0
    s_waitcnt vmcnt(0)
    v_mov_b32 v15, 32
    ds_write_b32 v14, v15 offset:4
L_wf_1:
    ds_read_b32 v15, v14 offset:8
    s_waitcnt lgkmcnt(0)
    v_readfirstlane_b32 s33, v15
    s_nop 0
    s_cmp_ge_u32 s33, 1
    s_cbranch_scc1 L_wfd_2
    s_sleep 2
    s_sub_u32 s32, s32, 1
    s_cbranch_scc1 L_exit
    s_branch L_wf_1
L_wfd_2:
    s_add_u32 s48, s63, 36992
    s_add_u32 s50, s26, s48
    s_addc_u32 s51, s27, 0
    s_mov_b32 s48, 1
    s_atomic_add s48, s[50:51], 0 glc
    s_waitcnt lgkmcnt(0)
    s_and_b32 s48, s48, 15
    s_add_u32 s48, s48, 1
    v_mov_b32 v15, s48
    ds_write_b32 v14, v15 offset:16
    s_branch L_S
L_rest:
    s_bfe_u32 s29, s2, 0x20003
    s_mov_b32 s32, 0x80000
    s_mov_b32 s34, 0x05040100
    s_mov_b32 s35, 0x07060302
    v_mov_b32 v14, 148992
    s_lshl_b32 s63, s28, 1
    s_lshr_b32 s61, s29, 1
    s_add_u32 s63, s63, s61
    s_mul_i32 s63, s63, 278528
    s_and_b32 s101, s29, 1
    s_and_b32 s31, s3, 3
    s_add_u32 s100, s28, 1
    s_and_b32 s100, s100, 7
    s_cmp_ge_u32 s3, 4
    s_cbranch_scc1 L_T
    s_cmp_eq_u32 s3, 2
    s_cbranch_scc1 L_W2
    s_cmp_eq_u32 s3, 3
    s_cbranch_scc1 L_W3
L_W1:
    v_bfe_u32 v1, v0, 2, 2
    v_lshlrev_b32 v1, 10, v1
    v_lshl_add_u32 v1, v12, 6, v1
    v_and_b32 v2, 3, v0
    v_lshl_add_u32 v2, v2, 4, v1
    v_bfe_u32 v4, v0, 3, 1
    v_lshl_add_u32 v4, v12, 2, v4
    v_lshlrev_b32 v4, 16, v4
    v_and_b32 v5, 7, v0
    v_lshl_add_u32 v4, v5, 4, v4
    s_lshl_b32 s48, s29, 20
    s_lshl_b32 s49, s100, 10
    s_add_u32 s48, s48, s49
    s_lshl_b32 s49, s30, 7
    s_add_u32 s48, s48, s49
    s_xor_b32 s52, s29, 0
    s_lshl_b32 s52, s52, 8
    s_xor_b32 s53, s29, 1
    s_lshl_b32 s53, s53, 8
    s_xor_b32 s54, s29, 2
    s_lshl_b32 s54, s54, 8
    s_xor_b32 s55, s29, 3
    s_lshl_b32 s55, s55, 8
    s_waitcnt lgkmcnt(0)
    s_load_dword s96, s[26:27], 0x9000
    s_mov_b32 s40, s4
    s_mov_b32 s41, s5
    s_mov_b32 s42, 0x1000
    s_mov_b32 s43, 0x20000
    s_mov_b32 s44, s10
    s_mov_b32 s45, s11
    s_mov_b32 s46, 0x400000
    s_mov_b32 s47, 0x20000
    s_mov_b32 s36, s26
    s_mov_b32 s37, s27
    s_mov_b32 s38, 0x460000
    s_mov_b32 s39, 0x20000
    s_or_b32 s49, s30, s101
    s_cbranch_scc1 L_W1t
    s_lshl_b32 s49, s100, 1
    s_lshr_b32 s51, s29, 1
    s_add_u32 s49, s49, s51
    s_mul_i32 s49, s49, 278528
    s_add_u32 s49, s49, 36992
    s_mov_b64 exec, 1
    v_mov_b32 v6, 0
    buffer_store_dword v6, v6, s[36:39], s49 offen sc1
    s_mov_b64 exec, -1
L_W1t:
    buffer_load_dwordx4 v[16:19], v2, s[40:43], s52 offen
    buffer_load_dwordx4 v[20:23], v2, s[40:43], s53 offen
    buffer_load_dwordx4 v[24:27], v2, s[40:43], s54 offen
    buffer_load_dwordx4 v[28:31], v2, s[40:43], s55 offen
    buffer_load_dwordx4 v[96:99], v4, s[44:47], s48 offen nt
    s_add_u32 s48, s48, 8192
    buffer_load_dwordx4 v[100:103], v4, s[44:47], s48 offen nt
    s_add_u32 s48, s48, 8192
    buffer_load_dwordx4 v[104:107], v4, s[44:47], s48 offen nt
    s_add_u32 s48, s48, 8192
    buffer_load_dwordx4 v[108:111], v4, s[44:47], s48 offen nt
    s_add_u32 s48, s48, 8192
    buffer_load_dwordx4 v[112:115], v4, s[44:47], s48 offen nt
    s_add_u32 s48, s48, 8192
    buffer_load_dwordx4 v[116:119], v4, s[44:47], s48 offen nt
    s_add_u32 s48, s48, 8192
    buffer_load_dwordx4 v[120:123], v4, s[44:47], s48 offen nt
    s_add_u32 s48, s48, 8192
    buffer_load_dwordx4 v[124:127], v4, s[44:47], s48 offen nt
    s_add_u32 s48, s48, 73728
    buffer_load_dwordx4 v[128:131], v4, s[44:47], s48 offen nt
    s_add_u32 s48, s48, 8192
    buffer_load_dwordx4 v[132:135], v4, s[44:47], s48 offen nt
    s_add_u32 s48, s48, 8192
    buffer_load_dwordx4 v[136:139], v4, s[44:47], s48 offen nt
    s_add_u32 s48, s48, 8192
    buffer_load_dwordx4 v[140:143], v4, s[44:47], s48 offen nt
    s_add_u32 s48, s48, 8192
    buffer_load_dwordx4 v[144:147], v4, s[44:47], s48 offen nt
    s_add_u32 s48, s48, 8192
    buffer_load_dwordx4 v[148:151], v4, s[44:47], s48 offen nt
    s_add_u32 s48, s48, 8192
    buffer_load_dwordx4 v[152:155], v4, s[44:47], s48 offen nt
    s_add_u32 s48, s48, 8192
    buffer_load_dwordx4 v[156:159], v4, s[44:47], s48 offen nt
    s_waitcnt lgkmcnt(0)
    s_add_u32 s96, s96, 0x01010101
    s_barrier
    s_waitcnt vmcnt(16)
    v_lshlrev_b32 v160, 16, v16
    v_and_b32 v161, 0xffff0000, v16
    v_lshlrev_b32 v162, 16, v17
    v_and_b32 v163, 0xffff0000, v17
    v_lshlrev_b32 v164, 16, v18
    v_and_b32 v165, 0xffff0000, v18
    v_lshlrev_b32 v166, 16, v19
    v_and_b32 v167, 0xffff0000, v19
    v_lshlrev_b32 v168, 16, v20
    v_and_b32 v169, 0xffff0000, v20
    v_lshlrev_b32 v170, 16, v21
    v_and_b32 v171, 0xffff0000, v21
    v_lshlrev_b32 v172, 16, v22
    v_and_b32 v173, 0xffff0000, v22
    v_lshlrev_b32 v174, 16, v23
    v_and_b32 v175, 0xffff0000, v23
    v_lshlrev_b32 v176, 16, v24
    v_and_b32 v177, 0xffff0000, v24
    v_lshlrev_b32 v178, 16, v25
    v_and_b32 v179, 0xffff0000, v25
    v_lshlrev_b32 v180, 16, v26
    v_and_b32 v181, 0xffff0000, v26
    v_lshlrev_b32 v182, 16, v27
    v_and_b32 v183, 0xffff0000, v27
    v_lshlrev_b32 v184, 16, v28
    v_and_b32 v185, 0xffff0000, v28
    v_lshlrev_b32 v186, 16, v29
    v_and_b32 v187, 0xffff0000, v29
    v_lshlrev_b32 v188, 16, v30
    v_and_b32 v189, 0xffff0000, v30
    v_lshlrev_b32 v190, 16, v31
    v_and_b32 v191, 0xffff0000, v31
    v_pk_add_f32 v[6:7], v[160:161], v[162:163]
    v_pk_add_f32 v[6:7], v[6:7], v[164:165]
    v_pk_add_f32 v[6:7], v[6:7], v[166:167]
    v_pk_add_f32 v[6:7], v[6:7], v[168:169]
    v_pk_add_f32 v[6:7], v[6:7], v[170:171]
    v_pk_add_f32 v[6:7], v[6:7], v[172:173]
    v_pk_add_f32 v[6:7], v[6:7], v[174:175]
    v_pk_add_f32 v[6:7], v[6:7], v[176:177]
    v_pk_add_f32 v[6:7], v[6:7], v[178:179]
    v_pk_add_f32 v[6:7], v[6:7], v[180:181]
    v_pk_add_f32 v[6:7], v[6:7], v[182:183]
    v_pk_add_f32 v[6:7], v[6:7], v[184:185]
    v_pk_add_f32 v[6:7], v[6:7], v[186:187]
    v_pk_add_f32 v[6:7], v[6:7], v[188:189]
    v_pk_add_f32 v[6:7], v[6:7], v[190:191]
    v_add_f32 v6, v6, v7
    s_nop 1
    v_add_f32_dpp v6, v6, v6 quad_perm:[1,0,3,2] row_mask:0xf bank_mask:0xf
    s_nop 1
    v_add_f32_dpp v6, v6, v6 quad_perm:[2,3,0,1] row_mask:0xf bank_mask:0xf
    v_mov_b32 v9, v6
    s_nop 1
    v_permlane16_swap_b32 v6, v9
    v_add_f32 v6, v6, v9
    v_mov_b32 v9, v6
    s_nop 1
    v_permlane32_swap_b32 v6, v9
    v_add_f32 v6, v6, v9
    v_mul_f32 v6, 0x3b000000, v6
    v_mov_b32 v7, 0
    v_sub_f32 v160, v160, v6
    v_sub_f32 v161, v161, v6
    v_sub_f32 v162, v162, v6
    v_sub_f32 v163, v163, v6
    v_sub_f32 v164, v164, v6
    v_sub_f32 v165, v165, v6
    v_sub_f32 v166, v166, v6
    v_sub_f32 v167, v167, v6
    v_sub_f32 v168, v168, v6
    v_sub_f32 v169, v169, v6
    v_sub_f32 v170, v170, v6
    v_sub_f32 v171, v171, v6
    v_sub_f32 v172, v172, v6
    v_sub_f32 v173, v173, v6
    v_sub_f32 v174, v174, v6
    v_sub_f32 v175, v175, v6
    v_sub_f32 v176, v176, v6
    v_sub_f32 v177, v177, v6
    v_sub_f32 v178, v178, v6
    v_sub_f32 v179, v179, v6
    v_sub_f32 v180, v180, v6
    v_sub_f32 v181, v181, v6
    v_sub_f32 v182, v182, v6
    v_sub_f32 v183, v183, v6
    v_sub_f32 v184, v184, v6
    v_sub_f32 v185, v185, v6
    v_sub_f32 v186, v186, v6
    v_sub_f32 v187, v187, v6
    v_sub_f32 v188, v188, v6
    v_sub_f32 v189, v189, v6
    v_sub_f32 v190, v190, v6
    v_sub_f32 v191, v191, v6
    v_fmac_f32 v7, v160, v160
    v_fmac_f32 v7, v161, v161
    v_fmac_f32 v7, v162, v162
    v_fmac_f32 v7, v163, v163
    v_fmac_f32 v7, v164, v164
    v_fmac_f32 v7, v165, v165
    v_fmac_f32 v7, v166, v166
    v_fmac_f32 v7, v167, v167
    v_fmac_f32 v7, v168, v168
    v_fmac_f32 v7, v169, v169
    v_fmac_f32 v7, v170, v170
    v_fmac_f32 v7, v171, v171
    v_fmac_f32 v7, v172, v172
    v_fmac_f32 v7, v173, v173
    v_fmac_f32 v7, v174, v174
    v_fmac_f32 v7, v175, v175
    v_fmac_f32 v7, v176, v176
    v_fmac_f32 v7, v177, v177
    v_fmac_f32 v7, v178, v178
    v_fmac_f32 v7, v179, v179
    v_fmac_f32 v7, v180, v180
    v_fmac_f32 v7, v181, v181
    v_fmac_f32 v7, v182, v182
    v_fmac_f32 v7, v183, v183
    v_fmac_f32 v7, v184, v184
    v_fmac_f32 v7, v185, v185
    v_fmac_f32 v7, v186, v186
    v_fmac_f32 v7, v187, v187
    v_fmac_f32 v7, v188, v188
    v_fmac_f32 v7, v189, v189
    v_fmac_f32 v7, v190, v190
    v_fmac_f32 v7, v191, v191
    s_nop 1
    v_add_f32_dpp v7, v7, v7 quad_perm:[1,0,3,2] row_mask:0xf bank_mask:0xf
    s_nop 1
    v_add_f32_dpp v7, v7, v7 quad_perm:[2,3,0,1] row_mask:0xf bank_mask:0xf
    v_mov_b32 v9, v7
    s_nop 1
    v_permlane16_swap_b32 v7, v9
    v_add_f32 v7, v7, v9
    v_mov_b32 v9, v7
    s_nop 1
    v_permlane32_swap_b32 v7, v9
    v_add_f32 v7, v7, v9
    v_mul_f32 v7, 0x3b000000, v7
    v_cvt_pk_bf16_f32 v6, v6, v6
    v_and_b32 v6, 0xffff0000, v6
    v_cvt_pk_bf16_f32 v7, v7, v7
    v_and_b32 v7, 0xffff0000, v7
    v_add_f32 v7, 0x3727c5ac, v7
    v_cvt_pk_bf16_f32 v7, v7, v7
    v_and_b32 v7, 0xffff0000, v7
    v_sqrt_f32 v7, v7
    s_nop 0
    v_cvt_pk_bf16_f32 v7, v7, v7
    v_and_b32 v7, 0xffff0000, v7
    v_rcp_f32 v7, v7
    v_lshlrev_b32 v8, 16, v16
    v_and_b32 v9, 0xffff0000, v16
    v_sub_f32 v8, v8, v6
    v_sub_f32 v9, v9, v6
    v_cvt_pk_bf16_f32 v9, v8, v9
    v_lshlrev_b32 v8, 16, v9
    v_and_b32 v9, 0xffff0000, v9
    v_mul_f32 v8, v8, v7
    v_mul_f32 v9, v9, v7
    v_cvt_pk_bf16_f32 v16, v8, v9
    v_lshlrev_b32 v8, 16, v17
    v_and_b32 v9, 0xffff0000, v17
    v_sub_f32 v8, v8, v6
    v_sub_f32 v9, v9, v6
    v_cvt_pk_bf16_f32 v9, v8, v9
    v_lshlrev_b32 v8, 16, v9
    v_and_b32 v9, 0xffff0000, v9
    v_mul_f32 v8, v8, v7
    v_mul_f32 v9, v9, v7
    v_cvt_pk_bf16_f32 v17, v8, v9
    v_lshlrev_b32 v8, 16, v18
    v_and_b32 v9, 0xffff0000, v18
    v_sub_f32 v8, v8, v6
    v_sub_f32 v9, v9, v6
    v_cvt_pk_bf16_f32 v9, v8, v9
    v_lshlrev_b32 v8, 16, v9
    v_and_b32 v9, 0xffff0000, v9
    v_mul_f32 v8, v8, v7
    v_mul_f32 v9, v9, v7
    v_cvt_pk_bf16_f32 v18, v8, v9
    v_lshlrev_b32 v8, 16, v19
    v_and_b32 v9, 0xffff0000, v19
    v_sub_f32 v8, v8, v6
    v_sub_f32 v9, v9, v6
    v_cvt_pk_bf16_f32 v9, v8, v9
    v_lshlrev_b32 v8, 16, v9
    v_and_b32 v9, 0xffff0000, v9
    v_mul_f32 v8, v8, v7
    v_mul_f32 v9, v9, v7
    v_cvt_pk_bf16_f32 v19, v8, v9
    v_mov_b32_dpp v32, v16 quad_perm:[0,1,0,1] row_mask:0xf bank_mask:0xf
    v_mov_b32_dpp v33, v17 quad_perm:[0,1,0,1] row_mask:0xf bank_mask:0xf
    v_mov_b32_dpp v34, v18 quad_perm:[0,1,0,1] row_mask:0xf bank_mask:0xf
    v_mov_b32_dpp v35, v19 quad_perm:[0,1,0,1] row_mask:0xf bank_mask:0xf
    v_mov_b32_dpp v36, v16 quad_perm:[2,3,2,3] row_mask:0xf bank_mask:0xf
    v_mov_b32_dpp v37, v17 quad_perm:[2,3,2,3] row_mask:0xf bank_mask:0xf
    v_mov_b32_dpp v38, v18 quad_perm:[2,3,2,3] row_mask:0xf bank_mask:0xf
    v_mov_b32_dpp v39, v19 quad_perm:[2,3,2,3] row_mask:0xf bank_mask:0xf
    s_waitcnt vmcnt(8)
    v_perm_b32 v64, v100, v96, s34
    v_perm_b32 v68, v100, v96, s35
    v_perm_b32 v72, v101, v97, s34
    v_perm_b32 v76, v101, v97, s35
    v_perm_b32 v80, v102, v98, s34
    v_perm_b32 v84, v102, v98, s35
    v_perm_b32 v88, v103, v99, s34
    v_perm_b32 v92, v103, v99, s35
    v_perm_b32 v65, v108, v104, s34
    v_perm_b32 v69, v108, v104, s35
    v_perm_b32 v73, v109, v105, s34
    v_perm_b32 v77, v109, v105, s35
    v_perm_b32 v81, v110, v106, s34
    v_perm_b32 v85, v110, v106, s35
    v_perm_b32 v89, v111, v107, s34
    v_perm_b32 v93, v111, v107, s35
    v_perm_b32 v66, v116, v112, s34
    v_perm_b32 v70, v116, v112, s35
    v_perm_b32 v74, v117, v113, s34
    v_perm_b32 v78, v117, v113, s35
    v_perm_b32 v82, v118, v114, s34
    v_perm_b32 v86, v118, v114, s35
    v_perm_b32 v90, v119, v115, s34
    v_perm_b32 v94, v119, v115, s35
    v_perm_b32 v67, v124, v120, s34
    v_perm_b32 v71, v124, v120, s35
    v_perm_b32 v75, v125, v121, s34
    v_perm_b32 v79, v125, v121, s35
    v_perm_b32 v83, v126, v122, s34
    v_perm_b32 v87, v126, v122, s35
    v_perm_b32 v91, v127, v123, s34
    v_perm_b32 v95, v127, v123, s35
    v_mfma_f32_16x16x32_bf16 v[192:195], v[32:35], v[64:67], 0
    v_mfma_f32_16x16x32_bf16 v[196:199], v[32:35], v[68:71], 0
    v_mfma_f32_16x16x32_bf16 v[200:203], v[32:35], v[72:75], 0
    v_mfma_f32_16x16x32_bf16 v[204:207], v[32:35], v[76:79], 0
    v_mfma_f32_16x16x32_bf16 v[208:211], v[32:35], v[80:83], 0
    v_mfma_f32_16x16x32_bf16 v[212:215], v[32:35], v[84:87], 0
    v_mfma_f32_16x16x32_bf16 v[216:219], v[32:35], v[88:91], 0
    v_mfma_f32_16x16x32_bf16 v[220:223], v[32:35], v[92:95], 0
    s_waitcnt vmcnt(0)
    v_perm_b32 v96, v132, v128, s34
    v_perm_b32 v100, v132, v128, s35
    v_perm_b32 v104, v133, v129, s34
    v_perm_b32 v108, v133, v129, s35
    v_perm_b32 v112, v134, v130, s34
    v_perm_b32 v116, v134, v130, s35
    v_perm_b32 v120, v135, v131, s34
    v_perm_b32 v124, v135, v131, s35
    v_perm_b32 v97, v140, v136, s34
    v_perm_b32 v101, v140, v136, s35
    v_perm_b32 v105, v141, v137, s34
    v_perm_b32 v109, v141, v137, s35
    v_perm_b32 v113, v142, v138, s34
    v_perm_b32 v117, v142, v138, s35
    v_perm_b32 v121, v143, v139, s34
    v_perm_b32 v125, v143, v139, s35
    v_perm_b32 v98, v148, v144, s34
    v_perm_b32 v102, v148, v144, s35
    v_perm_b32 v106, v149, v145, s34
    v_perm_b32 v110, v149, v145, s35
    v_perm_b32 v114, v150, v146, s34
    v_perm_b32 v118, v150, v146, s35
    v_perm_b32 v122, v151, v147, s34
    v_perm_b32 v126, v151, v147, s35
    v_perm_b32 v99, v156, v152, s34
    v_perm_b32 v103, v156, v152, s35
    v_perm_b32 v107, v157, v153, s34
    v_perm_b32 v111, v157, v153, s35
    v_perm_b32 v115, v158, v154, s34
    v_perm_b32 v119, v158, v154, s35
    v_perm_b32 v123, v159, v155, s34
    v_perm_b32 v127, v159, v155, s35
    v_mfma_f32_16x16x32_bf16 v[192:195], v[36:39], v[96:99], v[192:195]
    v_mfma_f32_16x16x32_bf16 v[196:199], v[36:39], v[100:103], v[196:199]
    v_mfma_f32_16x16x32_bf16 v[200:203], v[36:39], v[104:107], v[200:203]
    v_mfma_f32_16x16x32_bf16 v[204:207], v[36:39], v[108:111], v[204:207]
    v_mfma_f32_16x16x32_bf16 v[208:211], v[36:39], v[112:115], v[208:211]
    v_mfma_f32_16x16x32_bf16 v[212:215], v[36:39], v[116:119], v[212:215]
    v_mfma_f32_16x16x32_bf16 v[216:219], v[36:39], v[120:123], v[216:219]
    v_mfma_f32_16x16x32_bf16 v[220:223], v[36:39], v[124:127], v[220:223]
    v_lshrrev_b32 v1, 5, v0
    v_mul_u32_u24 v1, 278528, v1
    v_and_b32 v2, 1, v12
    v_lshl_add_u32 v1, v2, 13, v1
    v_lshl_add_u32 v1, v5, 5, v1
    v_bfe_u32 v2, v0, 3, 1
    v_lshl_add_u32 v1, v2, 4, v1
    s_mul_i32 s48, s100, 557056
    s_lshl_b32 s49, s29, 11
    s_add_u32 s48, s48, s49
    s_lshl_b32 s49, s30, 8
    s_add_u32 s48, s48, s49
    s_add_u32 s48, s48, 16384
    v_add_f32_dpp v16, v193, v192 row_ror:8 row_mask:0xf bank_mask:0x3
    v_add_f32_dpp v17, v197, v196 row_ror:8 row_mask:0xf bank_mask:0x3
    v_add_f32_dpp v18, v201, v200 row_ror:8 row_mask:0xf bank_mask:0x3
    v_add_f32_dpp v19, v205, v204 row_ror:8 row_mask:0xf bank_mask:0x3
    v_add_f32_dpp v16, v208, v209 row_ror:8 row_mask:0xf bank_mask:0xc
    v_add_f32_dpp v17, v212, v213 row_ror:8 row_mask:0xf bank_mask:0xc
    v_add_f32_dpp v18, v216, v217 row_ror:8 row_mask:0xf bank_mask:0xc
    v_add_f32_dpp v19, v220, v221 row_ror:8 row_mask:0xf bank_mask:0xc
    v_mov_b32 v6, s96
    s_mov_b32 s49, 0x7060500
    v_perm_b32 v16, v16, v6, s49
    s_mov_b32 s49, 0x7060501
    v_perm_b32 v17, v17, v6, s49
    s_mov_b32 s49, 0x7060502
    v_perm_b32 v18, v18, v6, s49
    s_mov_b32 s49, 0x7060503
    v_perm_b32 v19, v19, v6, s49
    buffer_store_dwordx4 v[16:19], v1, s[36:39], s48 offen sc1
    s_branch L_S
L_W2:
    v_lshlrev_b32 v2, 4, v0
    s_lshl_b32 s48, s101, 13
    s_add_u32 s48, s48, s63
    s_add_u32 s48, s48, 16384
    s_add_u32 s49, s48, 4096
    s_waitcnt lgkmcnt(0)
    s_load_dword s96, s[26:27], 0x9000
    s_mov_b32 s36, s26
    s_mov_b32 s37, s27
    s_mov_b32 s38, 0x460000
    s_mov_b32 s39, 0x20000
    s_waitcnt lgkmcnt(0)
    s_add_u32 s96, s96, 0x01010101
    s_barrier
    s_bfe_u32 s52, s96, 0x80000
    s_bfe_u32 s53, s96, 0x80008
    s_bfe_u32 s54, s96, 0x80010
    s_bfe_u32 s55, s96, 0x80018
L_wf_3:
    ds_read_b32 v15, v14 offset:4
    s_waitcnt lgkmcnt(0)
    v_readfirstlane_b32 s33, v15
    s_nop 0
    s_cmp_ge_u32 s33, 18
    s_cbranch_scc1 L_wfd_4
    s_sleep 4
    s_sub_u32 s32, s32, 1
    s_cbranch_scc1 L_exit
    s_branch L_wf_3
L_wfd_4:
L_W2p:
    buffer_load_dwordx4 v[16:19], v2, s[36:39], s48 offen offset:0 sc1
    buffer_load_dwordx4 v[20:23], v2, s[36:39], s48 offen offset:1024 sc1
    buffer_load_dwordx4 v[24:27], v2, s[36:39], s48 offen offset:2048 sc1
    buffer_load_dwordx4 v[28:31], v2, s[36:39], s48 offen offset:3072 sc1
    buffer_load_dwordx4 v[32:35], v2, s[36:39], s49 offen offset:0 sc1
    buffer_load_dwordx4 v[36:39], v2, s[36:39], s49 offen offset:1024 sc1
    buffer_load_dwordx4 v[40:43], v2, s[36:39], s49 offen offset:2048 sc1
    buffer_load_dwordx4 v[44:47], v2, s[36:39], s49 offen offset:3072 sc1
    s_waitcnt vmcnt(0)
    v_xor_b32 v16, s52, v16
    v_xor_b32 v17, s53, v17
    v_xor_b32 v18, s54, v18
    v_xor_b32 v19, s55, v19
    v_xor_b32 v20, s52, v20
    v_xor_b32 v21, s53, v21
    v_xor_b32 v22, s54, v22
    v_xor_b32 v23, s55, v23
    v_xor_b32 v24, s52, v24
    v_xor_b32 v25, s53, v25
    v_xor_b32 v26, s54, v26
    v_xor_b32 v27, s55, v27
    v_xor_b32 v28, s52, v28
    v_xor_b32 v29, s53, v29
    v_xor_b32 v30, s54, v30
    v_xor_b32 v31, s55, v31
    v_xor_b32 v32, s52, v32
    v_xor_b32 v33, s53, v33
    v_xor_b32 v34, s54, v34
    v_xor_b32 v35, s55, v35
    v_xor_b32 v36, s52, v36
    v_xor_b32 v37, s53, v37
    v_xor_b32 v38, s54, v38
    v_xor_b32 v39, s55, v39
    v_xor_b32 v40, s52, v40
    v_xor_b32 v41, s53, v41
    v_xor_b32 v42, s54, v42
    v_xor_b32 v43, s55, v43
    v_xor_b32 v44, s52, v44
    v_xor_b32 v45, s53, v45
    v_xor_b32 v46, s54, v46
    v_xor_b32 v47, s55, v47
    v_or_b32 v15, v16, v17
    v_or3_b32 v15, v15, v18, v19
    v_or3_b32 v15, v15, v20, v21
    v_or3_b32 v15, v15, v22, v23
    v_or3_b32 v15, v15, v24, v25
    v_or3_b32 v15, v15, v26, v27
    v_or3_b32 v15, v15, v28, v29
    v_or3_b32 v15, v15, v30, v31
    v_or3_b32 v15, v15, v32, v33
    v_or3_b32 v15, v15, v34, v35
    v_or3_b32 v15, v15, v36, v37
    v_or3_b32 v15, v15, v38, v39
    v_or3_b32 v15, v15, v40, v41
    v_or3_b32 v15, v15, v42, v43
    v_or3_b32 v15, v15, v44, v45
    v_or3_b32 v15, v15, v46, v47
    v_and_b32 v15, 0xff, v15
    v_cmp_ne_u32 vcc, 0, v15
    s_cbranch_vccz L_W2q
    s_sleep 4
    s_sub_u32 s32, s32, 1
    s_cbranch_scc1 L_exit
    s_branch L_W2p
L_W2q:
    v_pk_add_f32 v[16:17], v[16:17], v[24:25]
    v_pk_add_f32 v[18:19], v[18:19], v[26:27]
    v_pk_add_f32 v[16:17], v[16:17], v[32:33]
    v_pk_add_f32 v[18:19], v[18:19], v[34:35]
    v_pk_add_f32 v[16:17], v[16:17], v[40:41]
    v_pk_add_f32 v[18:19], v[18:19], v[42:43]
    v_cvt_pk_bf16_f32 v6, v16, v17
    v_cvt_pk_bf16_f32 v7, v18, v19
    v_pk_add_f32 v[20:21], v[20:21], v[28:29]
    v_pk_add_f32 v[22:23], v[22:23], v[30:31]
    v_pk_add_f32 v[20:21], v[20:21], v[36:37]
    v_pk_add_f32 v[22:23], v[22:23], v[38:39]
    v_pk_add_f32 v[20:21], v[20:21], v[44:45]
    v_pk_add_f32 v[22:23], v[22:23], v[46:47]
    v_cvt_pk_bf16_f32 v8, v20, v21
    v_cvt_pk_bf16_f32 v9, v22, v23
    v_lshlrev_b32 v1, 3, v0
    v_add_u32 v1, 131072, v1
    ds_write_b64 v1, v[6:7]
    ds_write_b64 v1, v[8:9] offset:512
    v_mov_b32 v15, 1
    ds_write_b32 v14, v15 offset:8
    s_branch L_S
L_W3:
    s_mov_b32 s100, s28
    s_mov_b32 s31, 0
    s_lshr_b32 s55, s2, 3
    s_getpc_b64 s[48:49]
L_pc:
    s_sub_u32 s48, s48, L_pc-sequential_preLN__sliding_block_cached__swiglu_ffn__decode_kernel
    s_subb_u32 s49, s49, 0
    s_mov_b32 s50, L_fin-sequential_preLN__sliding_block_cached__swiglu_ffn__decode_kernel-4
    s_lshl_b32 s51, s55, 9
    v_lshl_add_u32 v2, v0, 7, s51
    v_min_u32 v2, s50, v2
    s_mov_b64 exec, 15
    global_load_dword v16, v2, s[48:49]
    s_mov_b64 exec, -1
    v_lshl_add_u32 v1, v0, 2, v14
    v_mov_b32 v2, 0
    ds_write_b32 v1, v2
    s_waitcnt lgkmcnt(0)
    s_barrier
    v_and_b32 v1, 15, v0
    s_mul_i32 s49, s55, 16
    v_add_u32 v1, s49, v1
    s_lshl_b32 s49, s100, 19
    s_add_u32 s49, s49, 384
    v_lshl_add_u32 v1, v1, 10, s49
    s_mov_b64 exec, 0xffff
    global_load_dword v18, v1, s[12:13] sc1 nt
    global_load_dword v18, v1, s[12:13] sc1
    s_mov_b64 exec, -1
    v_and_b32 v1, 3, v0
    s_mul_i32 s49, s55, 4
    v_add_u32 v1, s49, v1
    v_lshrrev_b32 v2, 5, v1
    v_and_b32 v1, 31, v1
    v_lshl_add_u32 v1, v2, 7, v1
    v_add_u32 v1, 96, v1
    s_mul_i32 s49, s28, 448
    s_lshr_b32 s49, s49, 7
    s_or_b32 s49, s49, 3
    s_lshl_b32 s49, s49, 7
    v_mul_u32_u24 v1, 3584, v1
    v_add_u32 v1, s49, v1
    s_mov_b64 exec, 0xf
    global_load_dword v18, v1, s[16:17] sc1 nt
    global_load_dword v18, v1, s[16:17] sc1
    global_load_dword v18, v1, s[18:19] sc1 nt
    global_load_dword v18, v1, s[18:19] sc1
    s_mov_b64 exec, -1
L_S:
    s_mov_b32 s40, s8
    s_mov_b32 s41, s9
    s_mov_b32 s42, 0x8000000
    s_mov_b32 s43, 0x20000
    s_mov_b32 s36, s26
    s_mov_b32 s37, s27
    s_mov_b32 s38, 0x460000
    s_mov_b32 s39, 0x20000
    v_lshlrev_b32 v1, 4, v0
    s_lshl_b32 s48, s31, 18
    s_add_u32 s48, s48, s60
    s_add_u32 s49, s28, 0
    s_and_b32 s49, s49, 7
    s_lshl_b32 s49, s49, 12
    s_add_u32 s52, s49, s48
    s_add_u32 s49, s28, 1
    s_and_b32 s49, s49, 7
    s_lshl_b32 s49, s49, 12
    s_add_u32 s53, s49, s48
    s_add_u32 s49, s28, 2
    s_and_b32 s49, s49, 7
    s_lshl_b32 s49, s49, 12
    s_add_u32 s54, s49, s48
    s_add_u32 s49, s28, 3
    s_and_b32 s49, s49, 7
    s_lshl_b32 s49, s49, 12
    s_add_u32 s55, s49, s48
    s_add_u32 s49, s28, 4
    s_and_b32 s49, s49, 7
    s_lshl_b32 s49, s49, 12
    s_add_u32 s56, s49, s48
    s_add_u32 s49, s28, 5
    s_and_b32 s49, s49, 7
    s_lshl_b32 s49, s49, 12
    s_add_u32 s57, s49, s48
    s_add_u32 s49, s28, 6
    s_and_b32 s49, s49, 7
    s_lshl_b32 s49, s49, 12
    s_add_u32 s58, s49, s48
    s_add_u32 s49, s28, 7
    s_and_b32 s49, s49, 7
    s_lshl_b32 s49, s49, 12
    s_add_u32 s59, s49, s48
    v_lshrrev_b32 v2, 2, v13
    v_lshl_add_u32 v2, v12, 4, v2
    v_lshlrev_b32 v2, 4, v2
    s_lshl_b32 s49, s31, 10
    s_add_u32 s49, s49, 132096
    v_add_u32 v2, s49, v2
    s_lshl_b32 s49, s31, 11
    s_add_u32 s49, s49, 134144
    v_lshl_add_u32 v3, v0, 2, s49
    s_lshl_b32 s49, s31, 2
    v_add_u32 v5, s49, v14
    s_lshl_b32 s48, s101, 13
    s_lshl_b32 s49, s30, 10
    s_add_u32 s48, s48, s49
    s_add_u32 s48, s48, s63
    v_mov_b32 v32, 0
    v_mov_b32 v36, 0
    v_mov_b32 v40, 0
    v_mov_b32 v44, 0
    v_mov_b32 v48, 0
    v_mov_b32 v52, 0
    v_mov_b32 v56, 0
    v_mov_b32 v60, 0
    s_add_u32 s50, s31, 1
L_wf_5:
    ds_read_b32 v15, v14 offset:0
    s_waitcnt lgkmcnt(0)
    v_readfirstlane_b32 s33, v15
    s_nop 0
    s_cmp_ge_u32 s33, s50
    s_cbranch_scc1 L_wfd_6
    s_sleep 1
    s_sub_u32 s32, s32, 1
    s_cbranch_scc1 L_exit
    s_branch L_wf_5
L_wfd_6:
    buffer_load_dwordx4 v[96:99], v1, s[40:43], s52 offen offset:0 nt
    buffer_load_dwordx4 v[100:103], v1, s[40:43], s52 offen offset:1024 nt
    buffer_load_dwordx4 v[104:107], v1, s[40:43], s52 offen offset:2048 nt
    buffer_load_dwordx4 v[108:111], v1, s[40:43], s52 offen offset:3072 nt
    buffer_load_dwordx4 v[112:115], v1, s[40:43], s53 offen offset:0 nt
    buffer_load_dwordx4 v[116:119], v1, s[40:43], s53 offen offset:1024 nt
    buffer_load_dwordx4 v[120:123], v1, s[40:43], s53 offen offset:2048 nt
    buffer_load_dwordx4 v[124:127], v1, s[40:43], s53 offen offset:3072 nt
    buffer_load_dwordx4 v[128:131], v1, s[40:43], s54 offen offset:0 nt
    buffer_load_dwordx4 v[132:135], v1, s[40:43], s54 offen offset:1024 nt
    buffer_load_dwordx4 v[136:139], v1, s[40:43], s54 offen offset:2048 nt
    buffer_load_dwordx4 v[140:143], v1, s[40:43], s54 offen offset:3072 nt
    buffer_load_dwordx4 v[144:147], v1, s[40:43], s55 offen offset:0 nt
    buffer_load_dwordx4 v[148:151], v1, s[40:43], s55 offen offset:1024 nt
    buffer_load_dwordx4 v[152:155], v1, s[40:43], s55 offen offset:2048 nt
    buffer_load_dwordx4 v[156:159], v1, s[40:43], s55 offen offset:3072 nt
    buffer_load_dwordx4 v[160:163], v1, s[40:43], s56 offen offset:0 nt
    buffer_load_dwordx4 v[164:167], v1, s[40:43], s56 offen offset:1024 nt
    buffer_load_dwordx4 v[168:171], v1, s[40:43], s56 offen offset:2048 nt
    buffer_load_dwordx4 v[172:175], v1, s[40:43], s56 offen offset:3072 nt
    buffer_load_dwordx4 v[176:179], v1, s[40:43], s57 offen offset:0 nt
    buffer_load_dwordx4 v[180:183], v1, s[40:43], s57 offen offset:1024 nt
    buffer_load_dwordx4 v[184:187], v1, s[40:43], s57 offen offset:2048 nt
    buffer_load_dwordx4 v[188:191], v1, s[40:43], s57 offen offset:3072 nt
    s_waitcnt vmcnt(20)
    buffer_load_dwordx4 v[192:195], v1, s[40:43], s58 offen offset:0 nt
    buffer_load_dwordx4 v[196:199], v1, s[40:43], s58 offen offset:1024 nt
    buffer_load_dwordx4 v[200:203], v1, s[40:43], s58 offen offset:2048 nt
    buffer_load_dwordx4 v[204:207], v1, s[40:43], s58 offen offset:3072 nt
    s_waitcnt vmcnt(20)
    buffer_load_dwordx4 v[208:211], v1, s[40:43], s59 offen offset:0 nt
    buffer_load_dwordx4 v[212:215], v1, s[40:43], s59 offen offset:1024 nt
    buffer_load_dwordx4 v[216:219], v1, s[40:43], s59 offen offset:2048 nt
    buffer_load_dwordx4 v[220:223], v1, s[40:43], s59 offen offset:3072 nt
    s_add_u32 s51, s31, 2
    v_mov_b32 v15, s51
    ds_write_b32 v14, v15 offset:0
    s_setprio 3
    s_waitcnt vmcnt(24)
    v_perm_b32 v64, v100, v96, s34
    v_perm_b32 v68, v100, v96, s35
    v_perm_b32 v72, v101, v97, s34
    v_perm_b32 v76, v101, v97, s35
    v_perm_b32 v80, v102, v98, s34
    v_perm_b32 v84, v102, v98, s35
    v_perm_b32 v88, v103, v99, s34
    v_perm_b32 v92, v103, v99, s35
    v_perm_b32 v65, v108, v104, s34
    v_perm_b32 v69, v108, v104, s35
    v_perm_b32 v73, v109, v105, s34
    v_perm_b32 v77, v109, v105, s35
    v_perm_b32 v81, v110, v106, s34
    v_perm_b32 v85, v110, v106, s35
    v_perm_b32 v89, v111, v107, s34
    v_perm_b32 v93, v111, v107, s35
    v_perm_b32 v66, v116, v112, s34
    v_perm_b32 v70, v116, v112, s35
    v_perm_b32 v74, v117, v113, s34
    v_perm_b32 v78, v117, v113, s35
    v_perm_b32 v82, v118, v114, s34
    v_perm_b32 v86, v118, v114, s35
    v_perm_b32 v90, v119, v115, s34
    v_perm_b32 v94, v119, v115, s35
    v_perm_b32 v67, v124, v120, s34
    v_perm_b32 v71, v124, v120, s35
    v_perm_b32 v75, v125, v121, s34
    v_perm_b32 v79, v125, v121, s35
    v_perm_b32 v83, v126, v122, s34
    v_perm_b32 v87, v126, v122, s35
    v_perm_b32 v91, v127, v123, s34
    v_perm_b32 v95, v127, v123, s35
L_wf_7:
    ds_read_b32 v15, v5 offset:32
    s_waitcnt lgkmcnt(0)
    v_readfirstlane_b32 s33, v15
    s_nop 0
    s_cmp_ge_u32 s33, 1
    s_cbranch_scc1 L_wfd_8
    s_sleep 1
    s_sub_u32 s32, s32, 1
    s_cbranch_scc1 L_exit
    s_branch L_wf_7
L_wfd_8:
    ds_read_b128 v[16:19], v2 offset:0
    ds_read_b128 v[20:23], v2 offset:64
    ds_read_b128 v[24:27], v2 offset:128
    ds_read_b128 v[28:31], v2 offset:192
    s_cmp_eq_u32 s31, 0
    s_cbranch_scc1 L_Sc
L_wf_9:
    ds_read_b32 v15, v14 offset:12
    s_waitcnt lgkmcnt(0)
    v_readfirstlane_b32 s33, v15
    s_nop 0
    s_cmp_ge_u32 s33, s31
    s_cbranch_scc1 L_wfd_10
    s_sleep 1
    s_sub_u32 s32, s32, 1
    s_cbranch_scc1 L_exit
    s_branch L_wf_9
L_wfd_10:
    ds_read_b32 v32, v3 offset:0
    ds_read_b32 v36, v3 offset:256
    ds_read_b32 v40, v3 offset:512
    ds_read_b32 v44, v3 offset:768
    ds_read_b32 v48, v3 offset:1024
    ds_read_b32 v52, v3 offset:1280
    ds_read_b32 v56, v3 offset:1536
    ds_read_b32 v60, v3 offset:1792
L_Sc:
    s_waitcnt lgkmcnt(0)
    v_mfma_f32_16x16x32_bf16 v[32:35], v[16:19], v[64:67], v[32:35]
    v_mfma_f32_16x16x32_bf16 v[36:39], v[16:19], v[68:71], v[36:39]
    v_mfma_f32_16x16x32_bf16 v[40:43], v[16:19], v[72:75], v[40:43]
    v_mfma_f32_16x16x32_bf16 v[44:47], v[16:19], v[76:79], v[44:47]
    v_mfma_f32_16x16x32_bf16 v[48:51], v[16:19], v[80:83], v[48:51]
    v_mfma_f32_16x16x32_bf16 v[52:55], v[16:19], v[84:87], v[52:55]
    v_mfma_f32_16x16x32_bf16 v[56:59], v[16:19], v[88:91], v[56:59]
    v_mfma_f32_16x16x32_bf16 v[60:63], v[16:19], v[92:95], v[60:63]
    s_waitcnt vmcnt(16)
    v_perm_b32 v96, v132, v128, s34
    v_perm_b32 v100, v132, v128, s35
    v_perm_b32 v104, v133, v129, s34
    v_perm_b32 v108, v133, v129, s35
    v_perm_b32 v112, v134, v130, s34
    v_perm_b32 v116, v134, v130, s35
    v_perm_b32 v120, v135, v131, s34
    v_perm_b32 v124, v135, v131, s35
    v_perm_b32 v97, v140, v136, s34
    v_perm_b32 v101, v140, v136, s35
    v_perm_b32 v105, v141, v137, s34
    v_perm_b32 v109, v141, v137, s35
    v_perm_b32 v113, v142, v138, s34
    v_perm_b32 v117, v142, v138, s35
    v_perm_b32 v121, v143, v139, s34
    v_perm_b32 v125, v143, v139, s35
    v_perm_b32 v98, v148, v144, s34
    v_perm_b32 v102, v148, v144, s35
    v_perm_b32 v106, v149, v145, s34
    v_perm_b32 v110, v149, v145, s35
    v_perm_b32 v114, v150, v146, s34
    v_perm_b32 v118, v150, v146, s35
    v_perm_b32 v122, v151, v147, s34
    v_perm_b32 v126, v151, v147, s35
    v_perm_b32 v99, v156, v152, s34
    v_perm_b32 v103, v156, v152, s35
    v_perm_b32 v107, v157, v153, s34
    v_perm_b32 v111, v157, v153, s35
    v_perm_b32 v115, v158, v154, s34
    v_perm_b32 v119, v158, v154, s35
    v_perm_b32 v123, v159, v155, s34
    v_perm_b32 v127, v159, v155, s35
    v_mfma_f32_16x16x32_bf16 v[32:35], v[20:23], v[96:99], v[32:35]
    v_mfma_f32_16x16x32_bf16 v[36:39], v[20:23], v[100:103], v[36:39]
    v_mfma_f32_16x16x32_bf16 v[40:43], v[20:23], v[104:107], v[40:43]
    v_mfma_f32_16x16x32_bf16 v[44:47], v[20:23], v[108:111], v[44:47]
    v_mfma_f32_16x16x32_bf16 v[48:51], v[20:23], v[112:115], v[48:51]
    v_mfma_f32_16x16x32_bf16 v[52:55], v[20:23], v[116:119], v[52:55]
    v_mfma_f32_16x16x32_bf16 v[56:59], v[20:23], v[120:123], v[56:59]
    v_mfma_f32_16x16x32_bf16 v[60:63], v[20:23], v[124:127], v[60:63]
    s_waitcnt vmcnt(8)
    v_perm_b32 v128, v164, v160, s34
    v_perm_b32 v132, v164, v160, s35
    v_perm_b32 v136, v165, v161, s34
    v_perm_b32 v140, v165, v161, s35
    v_perm_b32 v144, v166, v162, s34
    v_perm_b32 v148, v166, v162, s35
    v_perm_b32 v152, v167, v163, s34
    v_perm_b32 v156, v167, v163, s35
    v_perm_b32 v129, v172, v168, s34
    v_perm_b32 v133, v172, v168, s35
    v_perm_b32 v137, v173, v169, s34
    v_perm_b32 v141, v173, v169, s35
    v_perm_b32 v145, v174, v170, s34
    v_perm_b32 v149, v174, v170, s35
    v_perm_b32 v153, v175, v171, s34
    v_perm_b32 v157, v175, v171, s35
    v_perm_b32 v130, v180, v176, s34
    v_perm_b32 v134, v180, v176, s35
    v_perm_b32 v138, v181, v177, s34
    v_perm_b32 v142, v181, v177, s35
    v_perm_b32 v146, v182, v178, s34
    v_perm_b32 v150, v182, v178, s35
    v_perm_b32 v154, v183, v179, s34
    v_perm_b32 v158, v183, v179, s35
    v_perm_b32 v131, v188, v184, s34
    v_perm_b32 v135, v188, v184, s35
    v_perm_b32 v139, v189, v185, s34
    v_perm_b32 v143, v189, v185, s35
    v_perm_b32 v147, v190, v186, s34
    v_perm_b32 v151, v190, v186, s35
    v_perm_b32 v155, v191, v187, s34
    v_perm_b32 v159, v191, v187, s35
    v_mfma_f32_16x16x32_bf16 v[32:35], v[24:27], v[128:131], v[32:35]
    v_mfma_f32_16x16x32_bf16 v[36:39], v[24:27], v[132:135], v[36:39]
    v_mfma_f32_16x16x32_bf16 v[40:43], v[24:27], v[136:139], v[40:43]
    v_mfma_f32_16x16x32_bf16 v[44:47], v[24:27], v[140:143], v[44:47]
    v_mfma_f32_16x16x32_bf16 v[48:51], v[24:27], v[144:147], v[48:51]
    v_mfma_f32_16x16x32_bf16 v[52:55], v[24:27], v[148:151], v[52:55]
    v_mfma_f32_16x16x32_bf16 v[56:59], v[24:27], v[152:155], v[56:59]
    v_mfma_f32_16x16x32_bf16 v[60:63], v[24:27], v[156:159], v[60:63]
    s_waitcnt vmcnt(6)
    v_perm_b32 v160, v196, v192, s34
    v_perm_b32 v164, v196, v192, s35
    v_perm_b32 v168, v197, v193, s34
    v_perm_b32 v172, v197, v193, s35
    v_perm_b32 v176, v198, v194, s34
    v_perm_b32 v180, v198, v194, s35
    v_perm_b32 v184, v199, v195, s34
    v_perm_b32 v188, v199, v195, s35
    s_waitcnt vmcnt(4)
    v_perm_b32 v161, v204, v200, s34
    v_perm_b32 v165, v204, v200, s35
    v_perm_b32 v169, v205, v201, s34
    v_perm_b32 v173, v205, v201, s35
    v_perm_b32 v177, v206, v202, s34
    v_perm_b32 v181, v206, v202, s35
    v_perm_b32 v185, v207, v203, s34
    v_perm_b32 v189, v207, v203, s35
    ds_read_b32 v15, v14 offset:28
    s_waitcnt vmcnt(2)
    v_perm_b32 v162, v212, v208, s34
    v_perm_b32 v166, v212, v208, s35
    v_perm_b32 v170, v213, v209, s34
    v_perm_b32 v174, v213, v209, s35
    v_perm_b32 v178, v214, v210, s34
    v_perm_b32 v182, v214, v210, s35
    v_perm_b32 v186, v215, v211, s34
    v_perm_b32 v190, v215, v211, s35
    s_waitcnt lgkmcnt(0)
    v_readfirstlane_b32 s61, v15
    s_waitcnt vmcnt(0)
    v_perm_b32 v163, v220, v216, s34
    v_perm_b32 v167, v220, v216, s35
    v_perm_b32 v171, v221, v217, s34
    v_perm_b32 v175, v221, v217, s35
    v_perm_b32 v179, v222, v218, s34
    v_perm_b32 v183, v222, v218, s35
    v_perm_b32 v187, v223, v219, s34
    v_perm_b32 v191, v223, v219, s35
    v_mfma_f32_16x16x32_bf16 v[32:35], v[28:31], v[160:163], v[32:35]
    v_mfma_f32_16x16x32_bf16 v[36:39], v[28:31], v[164:167], v[36:39]
    v_mfma_f32_16x16x32_bf16 v[40:43], v[28:31], v[168:171], v[40:43]
    v_mfma_f32_16x16x32_bf16 v[44:47], v[28:31], v[172:175], v[44:47]
    v_mfma_f32_16x16x32_bf16 v[48:51], v[28:31], v[176:179], v[48:51]
    v_mfma_f32_16x16x32_bf16 v[52:55], v[28:31], v[180:183], v[52:55]
    v_mfma_f32_16x16x32_bf16 v[56:59], v[28:31], v[184:187], v[56:59]
    v_mfma_f32_16x16x32_bf16 v[60:63], v[28:31], v[188:191], v[60:63]
    s_cmp_eq_u32 s31, 3
    s_cbranch_scc1 L_S3
    ds_write2st64_b32 v3, v32, v36 offset0:8 offset1:9
    s_nop 0
    ds_write2st64_b32 v3, v40, v44 offset0:10 offset1:11
    s_nop 0
    ds_write2st64_b32 v3, v48, v52 offset0:12 offset1:13
    s_nop 0
    ds_write2st64_b32 v3, v56, v60 offset0:14 offset1:15
    v_mov_b32 v15, s50
    ds_write_b32 v14, v15 offset:12
    s_cmp_lg_u32 s31, 1
    s_cbranch_scc1 L_exit
    s_setprio 0
L_wf_11:
    ds_read_b32 v15, v14 offset:0
    s_waitcnt lgkmcnt(0)
    v_readfirstlane_b32 s33, v15
    s_nop 0
    s_cmp_ge_u32 s33, 4
    s_cbranch_scc1 L_wfd_12
    s_sleep 2
    s_sub_u32 s32, s32, 1
    s_cbranch_scc1 L_exit
    s_branch L_wf_11
L_wfd_12:
    s_add_u32 s48, s63, 32768
    buffer_load_dwordx4 v[16:19], v1, s[36:39], s48 offen sc1
    s_getreg_b32 s49, hwreg(HW_REG_XCC_ID, 0, 4)
    s_waitcnt vmcnt(0)
    v_and_b32 v16, 0xffff, v16
    v_xor_b32 v16, s49, v16
    v_xor_b32 v17, s96, v17
    v_or_b32 v16, v16, v17
    v_cmp_ne_u32 vcc, 0, v16
    s_cbranch_vccnz L_exit
    v_mov_b32 v15, 1
    ds_write_b32 v14, v15 offset:28
    s_branch L_exit
L_S3:
    s_cmp_eq_u32 s61, 1
    v_cvt_pk_bf16_f32 v8, v32, v36
    v_min_u32 v8, -2, v8
    v_cvt_pk_bf16_f32 v9, v40, v44
    v_min_u32 v9, -2, v9
    v_cvt_pk_bf16_f32 v10, v48, v52
    v_min_u32 v10, -2, v10
    v_cvt_pk_bf16_f32 v11, v56, v60
    v_min_u32 v11, -2, v11
    s_cbranch_scc0 L_S3g
    buffer_store_dwordx4 v[8:11], v1, s[36:39], s48 offen
    s_branch L_S3h
L_S3g:
    buffer_store_dwordx4 v[8:11], v1, s[36:39], s48 offen sc1
L_S3h:
    v_mov_b32 v15, 6
    ds_write_b32 v14, v15 offset:0
    s_branch L_exit
L_T:
    s_mov_b32 s100, s28
    s_lshl_b32 s53, s31, 8
    s_and_b32 s62, s29, 2
    s_lshl_b32 s52, s62, 12
    s_add_u32 s52, s52, 49152
    s_lshr_b32 s51, s28, 2
    s_add_u32 s51, s51, 14
    s_mul_i32 s51, s51, 278528
    s_and_b32 s49, s28, 3
    s_lshl_b32 s49, s49, 10
    s_add_u32 s51, s51, s49
    s_add_u32 s51, s51, s52
    s_lshl_b32 s49, s30, 7
    s_add_u32 s51, s51, s49
    s_mul_i32 s61, s28, 7
    s_add_u32 s61, s61, s30
    s_add_u32 s55, s52, s53
    s_lshr_b32 s54, s61, 2
    s_mul_i32 s54, s54, 278528
    s_and_b32 s49, s61, 3
    s_lshl_b32 s49, s49, 10
    s_add_u32 s54, s54, s49
    s_add_u32 s54, s54, s55
    s_add_u32 s55, s55, 3899392
    s_lshl_b32 s50, s101, 13
    s_add_u32 s50, s50, s53
    s_add_u32 s50, s50, s63
    s_lshl_b32 s49, s30, 10
    s_add_u32 s50, s50, s49
    v_lshlrev_b32 v246, 12, v12
    v_lshl_add_u32 v246, v13, 4, v246
    v_mov_b32 v248, -1
    v_mov_b32 v249, -1
    v_mov_b32 v250, -1
    v_mov_b32 v251, -1
    s_waitcnt lgkmcnt(0)
    s_load_dword s96, s[26:27], 0x9000
    s_mov_b32 s36, s26
    s_mov_b32 s37, s27
    s_mov_b32 s38, 0x460000
    s_mov_b32 s39, 0x20000
    s_mov_b64 exec, 0xffff
    buffer_store_dwordx4 v[248:251], v246, s[36:39], s50 offen sc1
    s_cmp_eq_u32 s101, 1
    s_cbranch_scc1 L_Tc1
    s_cmp_lg_u32 s31, 3
    s_cbranch_scc1 L_Tc2
    s_mov_b64 exec, 0x00ff00ff
    buffer_store_dwordx4 v[248:251], v246, s[36:39], s51 offen sc1
    s_lshl_b32 s11, s28, 2
    s_add_u32 s11, s11, s62
    s_lshl_b32 s11, s11, 12
    s_add_u32 s11, s11, 4456448
    s_lshl_b32 s49, s30, 7
    s_add_u32 s11, s11, s49
    buffer_store_dwordx4 v[248:251], v246, s[36:39], s11 offen
    s_branch L_Tc2
L_Tc1:
    s_cmp_eq_u32 s30, 7
    s_cbranch_scc1 L_Tc2
    s_mov_b32 exec_lo, -1
    buffer_store_dwordx4 v[248:251], v246, s[36:39], s54 offen sc1
L_Tc2:
    s_mov_b64 exec, -1
    s_waitcnt lgkmcnt(0)
    s_add_u32 s96, s96, 0x01010101
    s_barrier
    v_and_b32 v1, 3, v0
    v_lshlrev_b32 v1, 8, v1
    v_lshl_add_u32 v1, v12, 4, v1
    v_add_u32 v1, 131072, v1
    v_and_b32 v8, 3, v0
    v_lshlrev_b32 v8, 2, v8
    v_lshrrev_b32 v9, 2, v13
    v_add_u32 v8, v8, v9
    v_lshlrev_b32 v8, 8, v8
    s_lshl_b32 s57, s31, 15
    v_add_u32 v8, s57, v8
    v_add_u32 v9, 0, v12
    v_xor_b32 v9, v9, v13
    v_lshl_add_u32 v4, v9, 4, v8
    v_add_u32 v9, 4, v12
    v_xor_b32 v9, v9, v13
    v_lshl_add_u32 v5, v9, 4, v8
    v_add_u32 v9, 8, v12
    v_xor_b32 v9, v9, v13
    v_lshl_add_u32 v6, v9, 4, v8
    v_add_u32 v9, 12, v12
    v_xor_b32 v9, v9, v13
    v_lshl_add_u32 v7, v9, 4, v8
L_wf_13:
    ds_read_b32 v15, v14 offset:8
    s_waitcnt lgkmcnt(0)
    v_readfirstlane_b32 s33, v15
    s_nop 0
    s_cmp_ge_u32 s33, 1
    s_cbranch_scc1 L_wfd_14
    s_sleep 2
    s_sub_u32 s32, s32, 1
    s_cbranch_scc1 L_exit
    s_branch L_wf_13
L_wfd_14:
    ds_read_b128 v[16:19], v1 offset:0
    ds_read_b128 v[20:23], v1 offset:64
    ds_read_b128 v[24:27], v1 offset:128
    ds_read_b128 v[28:31], v1 offset:192
    s_add_u32 s48, s31, 1
    s_lshl_b32 s48, s48, 3
L_wf_15:
    ds_read_b32 v15, v14 offset:4
    s_waitcnt lgkmcnt(0)
    v_readfirstlane_b32 s33, v15
    s_nop 0
    s_cmp_ge_u32 s33, s48
    s_cbranch_scc1 L_wfd_16
    s_sleep 2
    s_sub_u32 s32, s32, 1
    s_cbranch_scc1 L_exit
    s_branch L_wf_15
L_wfd_16:
    ds_read_b128 v[64:67], v4 offset:0
    ds_read_b128 v[68:71], v5 offset:0
    ds_read_b128 v[72:75], v6 offset:0
    ds_read_b128 v[76:79], v7 offset:0
    ds_read_b128 v[80:83], v4 offset:4096
    ds_read_b128 v[84:87], v5 offset:4096
    ds_read_b128 v[88:91], v6 offset:4096
    ds_read_b128 v[92:95], v7 offset:4096
    ds_read_b128 v[96:99], v4 offset:8192
    ds_read_b128 v[100:103], v5 offset:8192
    ds_read_b128 v[104:107], v6 offset:8192
    ds_read_b128 v[108:111], v7 offset:8192
    s_waitcnt lgkmcnt(8)
    v_mfma_f32_16x16x32_bf16 v[32:35], v[64:67], v[16:19], 0
    v_mfma_f32_16x16x32_bf16 v[32:35], v[68:71], v[20:23], v[32:35]
    v_mfma_f32_16x16x32_bf16 v[32:35], v[72:75], v[24:27], v[32:35]
    v_mfma_f32_16x16x32_bf16 v[32:35], v[76:79], v[28:31], v[32:35]
    ds_read_b128 v[112:115], v4 offset:12288
    ds_read_b128 v[116:119], v5 offset:12288
    ds_read_b128 v[120:123], v6 offset:12288
    ds_read_b128 v[124:127], v7 offset:12288
    s_waitcnt lgkmcnt(8)
    v_mfma_f32_16x16x32_bf16 v[36:39], v[80:83], v[16:19], 0
    v_mfma_f32_16x16x32_bf16 v[36:39], v[84:87], v[20:23], v[36:39]
    v_mfma_f32_16x16x32_bf16 v[36:39], v[88:91], v[24:27], v[36:39]
    v_mfma_f32_16x16x32_bf16 v[36:39], v[92:95], v[28:31], v[36:39]
    ds_read_b128 v[128:131], v4 offset:16384
    ds_read_b128 v[132:135], v5 offset:16384
    ds_read_b128 v[136:139], v6 offset:16384
    ds_read_b128 v[140:143], v7 offset:16384
    s_waitcnt lgkmcnt(8)
    v_mfma_f32_16x16x32_bf16 v[40:43], v[96:99], v[16:19], 0
    v_mfma_f32_16x16x32_bf16 v[40:43], v[100:103], v[20:23], v[40:43]
    v_mfma_f32_16x16x32_bf16 v[40:43], v[104:107], v[24:27], v[40:43]
    v_mfma_f32_16x16x32_bf16 v[40:43], v[108:111], v[28:31], v[40:43]
    ds_read_b128 v[144:147], v4 offset:20480
    ds_read_b128 v[148:151], v5 offset:20480
    ds_read_b128 v[152:155], v6 offset:20480
    ds_read_b128 v[156:159], v7 offset:20480
    s_waitcnt lgkmcnt(8)
    v_mfma_f32_16x16x32_bf16 v[44:47], v[112:115], v[16:19], 0
    v_mfma_f32_16x16x32_bf16 v[44:47], v[116:119], v[20:23], v[44:47]
    v_mfma_f32_16x16x32_bf16 v[44:47], v[120:123], v[24:27], v[44:47]
    v_mfma_f32_16x16x32_bf16 v[44:47], v[124:127], v[28:31], v[44:47]
    ds_read_b128 v[160:163], v4 offset:24576
    ds_read_b128 v[164:167], v5 offset:24576
    ds_read_b128 v[168:171], v6 offset:24576
    ds_read_b128 v[172:175], v7 offset:24576
    s_waitcnt lgkmcnt(8)
    v_mfma_f32_16x16x32_bf16 v[48:51], v[128:131], v[16:19], 0
    v_mfma_f32_16x16x32_bf16 v[48:51], v[132:135], v[20:23], v[48:51]
    v_mfma_f32_16x16x32_bf16 v[48:51], v[136:139], v[24:27], v[48:51]
    v_mfma_f32_16x16x32_bf16 v[48:51], v[140:143], v[28:31], v[48:51]
    ds_read_b128 v[176:179], v4 offset:28672
    ds_read_b128 v[180:183], v5 offset:28672
    ds_read_b128 v[184:187], v6 offset:28672
    ds_read_b128 v[188:191], v7 offset:28672
    s_waitcnt lgkmcnt(8)
    v_mfma_f32_16x16x32_bf16 v[52:55], v[144:147], v[16:19], 0
    v_mfma_f32_16x16x32_bf16 v[52:55], v[148:151], v[20:23], v[52:55]
    v_mfma_f32_16x16x32_bf16 v[52:55], v[152:155], v[24:27], v[52:55]
    v_mfma_f32_16x16x32_bf16 v[52:55], v[156:159], v[28:31], v[52:55]
    s_waitcnt lgkmcnt(4)
    v_mfma_f32_16x16x32_bf16 v[56:59], v[160:163], v[16:19], 0
    v_mfma_f32_16x16x32_bf16 v[56:59], v[164:167], v[20:23], v[56:59]
    v_mfma_f32_16x16x32_bf16 v[56:59], v[168:171], v[24:27], v[56:59]
    v_mfma_f32_16x16x32_bf16 v[56:59], v[172:175], v[28:31], v[56:59]
    s_waitcnt lgkmcnt(0)
    v_mfma_f32_16x16x32_bf16 v[60:63], v[176:179], v[16:19], 0
    v_mfma_f32_16x16x32_bf16 v[60:63], v[180:183], v[20:23], v[60:63]
    v_mfma_f32_16x16x32_bf16 v[60:63], v[184:187], v[24:27], v[60:63]
    v_mfma_f32_16x16x32_bf16 v[60:63], v[188:191], v[28:31], v[60:63]
    v_mov_b32_dpp v32, v40 quad_perm:[0,1,2,3] row_mask:0xf bank_mask:0x2
    v_mov_b32_dpp v33, v41 quad_perm:[0,1,2,3] row_mask:0xf bank_mask:0x2
    v_mov_b32_dpp v34, v42 quad_perm:[0,1,2,3] row_mask:0xf bank_mask:0x2
    v_mov_b32_dpp v35, v43 quad_perm:[0,1,2,3] row_mask:0xf bank_mask:0x2
    v_mov_b32_dpp v36, v44 quad_perm:[0,1,2,3] row_mask:0xf bank_mask:0x2
    v_mov_b32_dpp v37, v45 quad_perm:[0,1,2,3] row_mask:0xf bank_mask:0x2
    v_mov_b32_dpp v38, v46 quad_perm:[0,1,2,3] row_mask:0xf bank_mask:0x2
    v_mov_b32_dpp v39, v47 quad_perm:[0,1,2,3] row_mask:0xf bank_mask:0x2
    v_mov_b32_dpp v32, v48 quad_perm:[0,1,2,3] row_mask:0xf bank_mask:0x4
    v_mov_b32_dpp v33, v49 quad_perm:[0,1,2,3] row_mask:0xf bank_mask:0x4
    v_mov_b32_dpp v34, v50 quad_perm:[0,1,2,3] row_mask:0xf bank_mask:0x4
    v_mov_b32_dpp v35, v51 quad_perm:[0,1,2,3] row_mask:0xf bank_mask:0x4
    v_mov_b32_dpp v36, v52 quad_perm:[0,1,2,3] row_mask:0xf bank_mask:0x4
    v_mov_b32_dpp v37, v53 quad_perm:[0,1,2,3] row_mask:0xf bank_mask:0x4
    v_mov_b32_dpp v38, v54 quad_perm:[0,1,2,3] row_mask:0xf bank_mask:0x4
    v_mov_b32_dpp v39, v55 quad_perm:[0,1,2,3] row_mask:0xf bank_mask:0x4
    v_mov_b32_dpp v32, v56 quad_perm:[0,1,2,3] row_mask:0xf bank_mask:0x8
    v_mov_b32_dpp v33, v57 quad_perm:[0,1,2,3] row_mask:0xf bank_mask:0x8
    v_mov_b32_dpp v34, v58 quad_perm:[0,1,2,3] row_mask:0xf bank_mask:0x8
    v_mov_b32_dpp v35, v59 quad_perm:[0,1,2,3] row_mask:0xf bank_mask:0x8
    v_mov_b32_dpp v36, v60 quad_perm:[0,1,2,3] row_mask:0xf bank_mask:0x8
    v_mov_b32_dpp v37, v61 quad_perm:[0,1,2,3] row_mask:0xf bank_mask:0x8
    v_mov_b32_dpp v38, v62 quad_perm:[0,1,2,3] row_mask:0xf bank_mask:0x8
    v_mov_b32_dpp v39, v63 quad_perm:[0,1,2,3] row_mask:0xf bank_mask:0x8
    s_mov_b32 s50, 0x3db504f3
    s_mov_b32 s59, 0x3fb8aa3b
    v_cvt_pk_bf16_f32 v33, v32, v33
    v_lshlrev_b32 v32, 16, v33
    v_and_b32 v33, 0xffff0000, v33
    v_mul_f32 v32, s50, v32
    v_mul_f32 v33, s50, v33
    v_cvt_pk_bf16_f32 v33, v32, v33
    v_lshlrev_b32 v32, 16, v33
    v_and_b32 v33, 0xffff0000, v33
    v_cvt_pk_bf16_f32 v35, v34, v35
    v_lshlrev_b32 v34, 16, v35
    v_and_b32 v35, 0xffff0000, v35
    v_mul_f32 v34, s50, v34
    v_mul_f32 v35, s50, v35
    v_cvt_pk_bf16_f32 v35, v34, v35
    v_lshlrev_b32 v34, 16, v35
    v_and_b32 v35, 0xffff0000, v35
    v_cvt_pk_bf16_f32 v37, v36, v37
    v_lshlrev_b32 v36, 16, v37
    v_and_b32 v37, 0xffff0000, v37
    v_mul_f32 v36, s50, v36
    v_mul_f32 v37, s50, v37
    v_cvt_pk_bf16_f32 v37, v36, v37
    v_lshlrev_b32 v36, 16, v37
    v_and_b32 v37, 0xffff0000, v37
    v_cvt_pk_bf16_f32 v39, v38, v39
    v_lshlrev_b32 v38, 16, v39
    v_and_b32 v39, 0xffff0000, v39
    v_mul_f32 v38, s50, v38
    v_mul_f32 v39, s50, v39
    v_cvt_pk_bf16_f32 v39, v38, v39
    v_lshlrev_b32 v38, 16, v39
    v_and_b32 v39, 0xffff0000, v39
    v_max3_f32 v8, v32, v33, v34
    v_max3_f32 v8, v8, v35, v36
    v_max3_f32 v8, v8, v37, v38
    v_max_f32 v8, v8, v39
    s_nop 1
    v_max_f32_dpp v8, v8, v8 row_ror:4 row_mask:0xf bank_mask:0xf
    s_nop 1
    v_max_f32_dpp v8, v8, v8 row_ror:8 row_mask:0xf bank_mask:0xf
    v_mov_b32 v10, v8
    s_nop 1
    v_permlane16_swap_b32 v8, v10
    v_max_f32 v8, v8, v10
    v_mov_b32 v10, v8
    s_nop 1
    v_permlane32_swap_b32 v8, v10
    v_max_f32 v8, v8, v10
    v_and_b32 v5, 3, v0
    v_lshlrev_b32 v5, 4, v5
    v_add_u32 v5, 148864, v5
    s_lshl_b32 s48, s31, 2
    v_add_u32 v6, s48, v5
    s_waitcnt vmcnt(0)
    s_mov_b64 exec, 15
    ds_write_b32 v6, v8
    s_mov_b64 exec, 1
    v_mov_b32 v15, 1
    ds_add_u32 v14, v15 offset:20
    s_mov_b64 exec, -1
L_wf_17:
    ds_read_b32 v15, v14 offset:20
    s_waitcnt lgkmcnt(0)
    v_readfirstlane_b32 s33, v15
    s_nop 0
    s_cmp_ge_u32 s33, 4
    s_cbranch_scc1 L_wfd_18
    s_sleep 1
    s_sub_u32 s32, s32, 1
    s_cbranch_scc1 L_exit
    s_branch L_wf_17
L_wfd_18:
    ds_read_b128 v[16:19], v5
    s_waitcnt lgkmcnt(0)
    v_max3_f32 v8, v16, v17, v18
    v_max_f32 v8, v8, v19
    v_sub_f32 v40, v32, v8
    v_sub_f32 v41, v33, v8
    v_sub_f32 v42, v34, v8
    v_sub_f32 v43, v35, v8
    v_sub_f32 v44, v36, v8
    v_sub_f32 v45, v37, v8
    v_sub_f32 v46, v38, v8
    v_sub_f32 v47, v39, v8
    v_mul_f32 v40, s59, v40
    v_mul_f32 v41, s59, v41
    v_mul_f32 v42, s59, v42
    v_mul_f32 v43, s59, v43
    v_mul_f32 v44, s59, v44
    v_mul_f32 v45, s59, v45
    v_mul_f32 v46, s59, v46
    v_mul_f32 v47, s59, v47
    v_exp_f32 v40, v40
    v_exp_f32 v41, v41
    v_exp_f32 v42, v42
    v_exp_f32 v43, v43
    v_exp_f32 v44, v44
    v_exp_f32 v45, v45
    v_exp_f32 v46, v46
    v_exp_f32 v47, v47
    v_lshlrev_b32 v4, 4, v0
    v_cvt_pk_bf16_f32 v16, v40, v41
    v_cvt_pk_bf16_f32 v17, v42, v43
    v_cvt_pk_bf16_f32 v18, v44, v45
    v_cvt_pk_bf16_f32 v19, v46, v47
    s_lshl_b32 s49, s31, 10
    s_add_u32 s49, s49, 132096
    v_add_u32 v7, s49, v4
    ds_write_b128 v7, v[16:19]
    v_add_u32 v7, s48, v14
    v_mov_b32 v15, 1
    ds_write_b32 v7, v15 offset:32
    v_add_f32 v9, v40, v41
    v_add_f32 v9, v9, v42
    v_add_f32 v9, v9, v43
    v_add_f32 v9, v9, v44
    v_add_f32 v9, v9, v45
    v_add_f32 v9, v9, v46
    v_add_f32 v9, v9, v47
    s_nop 1
    v_add_f32_dpp v9, v9, v9 row_ror:4 row_mask:0xf bank_mask:0xf
    s_nop 1
    v_add_f32_dpp v9, v9, v9 row_ror:8 row_mask:0xf bank_mask:0xf
    v_mov_b32 v10, v9
    s_nop 1
    v_permlane16_swap_b32 v9, v10
    v_add_f32 v9, v9, v10
    v_mov_b32 v10, v9
    s_nop 1
    v_permlane32_swap_b32 v9, v10
    v_add_f32 v9, v9, v10
    s_mov_b64 exec, 15
    ds_write_b32 v6, v9 offset:64
    s_mov_b64 exec, 1
    v_mov_b32 v15, 1
    ds_add_rtn_u32 v15, v14, v15 offset:24
    s_mov_b64 exec, -1
    s_waitcnt lgkmcnt(0)
    v_readfirstlane_b32 s33, v15
    s_nop 0
    s_cmp_lg_u32 s33, 3
    s_cbranch_scc1 L_Tst
    ds_read_b128 v[16:19], v5 offset:64
    s_lshl_b32 s49, s101, 3
    s_add_u32 s49, s49, s30
    s_lshl_b32 s49, s49, 6
    s_add_u32 s49, s49, s63
    s_add_u32 s49, s49, 32768
    s_getreg_b32 s33, hwreg(HW_REG_XCC_ID, 0, 4)
    v_and_b32 v8, 0xffff0000, v8
    v_or_b32 v8, s33, v8
    v_mov_b32 v20, v8
    v_mov_b32 v21, s96
    v_mov_b32 v23, s96
    s_waitcnt lgkmcnt(0)
    v_add_f32 v16, v16, v17
    v_add_f32 v18, v18, v19
    v_add_f32 v22, v16, v18
    s_mov_b64 exec, 15
    buffer_store_dwordx4 v[20:23], v4, s[36:39], s49 offen sc1
    s_mov_b64 exec, -1
L_Tst:
    v_bfe_u32 v8, v0, 3, 1
    v_and_b32 v9, 1, v12
    v_lshl_add_u32 v8, v9, 1, v8
    v_lshlrev_b32 v9, 10, v12
    v_bfe_u32 v10, v0, 2, 2
    v_lshl_add_u32 v9, v10, 7, v9
    v_and_b32 v10, 3, v0
    v_lshl_add_u32 v9, v10, 3, v9
    v_add_u32 v9, s57, v9
    v_xor_b32 v10, 0, v8
    v_lshl_add_u32 v4, v10, 5, v9
    v_xor_b32 v10, 1, v8
    v_lshl_add_u32 v5, v10, 5, v9
    v_xor_b32 v10, 2, v8
    v_lshl_add_u32 v6, v10, 5, v9
    v_xor_b32 v10, 3, v8
    v_lshl_add_u32 v7, v10, 5, v9
    s_add_u32 s56, s57, 16384
    v_lshl_add_u32 v9, v13, 8, s56
    v_add_u32 v10, 0, v12
    v_xor_b32 v10, v10, v13
    v_lshl_add_u32 v60, v10, 4, v9
    v_lshlrev_b32 v10, 4, v10
    v_lshl_add_u32 v252, v12, 10, v10
    v_add_u32 v10, 4, v12
    v_xor_b32 v10, v10, v13
    v_lshl_add_u32 v61, v10, 4, v9
    v_lshlrev_b32 v10, 4, v10
    v_lshl_add_u32 v253, v12, 10, v10
    v_add_u32 v10, 8, v12
    v_xor_b32 v10, v10, v13
    v_lshl_add_u32 v62, v10, 4, v9
    v_lshlrev_b32 v10, 4, v10
    v_lshl_add_u32 v254, v12, 10, v10
    v_add_u32 v10, 12, v12
    v_xor_b32 v10, v10, v13
    v_lshl_add_u32 v63, v10, 4, v9
    v_lshlrev_b32 v10, 4, v10
    v_lshl_add_u32 v255, v12, 10, v10
    v_bfe_u32 v8, v0, 4, 1
    v_lshlrev_b32 v8, 1, v8
    v_and_b32 v9, 7, v0
    v_xor_b32 v8, v8, v9
    v_lshrrev_b32 v9, 3, v0
L_wf_19:
    ds_read_b32 v15, v14 offset:16
    s_waitcnt lgkmcnt(0)
    v_readfirstlane_b32 s33, v15
    s_nop 0
    s_cmp_ge_u32 s33, 1
    s_cbranch_scc1 L_wfd_20
    s_sleep 2
    s_sub_u32 s32, s32, 1
    s_cbranch_scc1 L_exit
    s_branch L_wf_19
L_wfd_20:
    s_sub_u32 s97, s33, 1
    s_cmp_eq_u32 s97, 15
    s_cbranch_scc1 L_exit
    s_cmp_lt_u32 s97, 7
    s_cbranch_scc1 L_F
    s_add_u32 s30, s97, 5
    s_and_b32 s30, s30, 7
    s_lshr_b32 s51, s100, 2
    s_add_u32 s51, s51, 14
    s_mul_i32 s51, s51, 278528
    s_and_b32 s49, s100, 3
    s_lshl_b32 s49, s49, 10
    s_add_u32 s51, s51, s49
    s_add_u32 s51, s51, s52
    s_lshl_b32 s49, s30, 7
    s_add_u32 s51, s51, s49
    s_lshl_b32 s11, s100, 2
    s_add_u32 s11, s11, s62
    s_lshl_b32 s11, s11, 12
    s_add_u32 s11, s11, 4456448
    s_lshl_b32 s49, s30, 7
    s_add_u32 s11, s11, s49
    s_mov_b32 s40, s12
    s_mov_b32 s41, s13
    s_mov_b32 s42, 0x400000
    s_mov_b32 s43, 0x20000
    v_lshlrev_b32 v2, 10, v9
    v_lshl_add_u32 v2, v8, 4, v2
    v_xor_b32 v3, 64, v2
    s_lshl_b32 s63, s100, 1
    s_lshr_b32 s49, s29, 1
    s_add_u32 s63, s63, s49
    s_mul_i32 s63, s63, 278528
    s_add_u32 s60, s63, s53
    s_add_u32 s58, s63, 32768
    s_add_u32 s61, s60, 4096
    s_add_u32 s54, s60, 8192
    s_add_u32 s55, s60, 12288
    s_lshl_b32 s48, s100, 19
    s_lshl_b32 s49, s31, 17
    s_add_u32 s48, s48, s49
    s_lshl_b32 s49, s30, 7
    s_add_u32 s48, s48, s49
    s_mov_b32 s44, s4
    s_mov_b32 s45, s5
    s_cmp_eq_u32 s100, 0
    s_cselect_b32 s46, 4096, 0
    s_mov_b32 s47, 0x20000
    s_lshl_b32 s50, s62, 10
    s_add_u32 s50, s50, s49
    v_lshrrev_b32 v8, 5, v0
    v_bfe_u32 v9, v0, 1, 4
    v_lshlrev_b32 v10, 3, v9
    v_lshl_add_u32 v11, v8, 10, v10
    v_lshl_add_u32 v59, v8, 12, v10
    buffer_load_dwordx2 v[56:57], v11, s[44:47], s50 offen
    v_and_b32 v10, 1, v0
    v_lshl_add_u32 v58, v8, 1, v10
    v_mul_u32_u24 v58, 320, v58
    v_lshl_add_u32 v58, v9, 4, v58
    v_add_u32 v58, 142336, v58
    v_mul_u32_u24 v247, 320, v12
    v_lshl_add_u32 v247, v13, 2, v247
    s_mul_i32 s49, s31, 1280
    s_add_u32 s49, s49, 142336
    v_add_u32 v247, s49, v247
    v_lshrrev_b32 v11, 2, v0
    v_lshlrev_b32 v11, 6, v11
    s_lshl_b32 s49, s31, 4
    s_add_u32 s58, s58, s49
    v_lshlrev_b32 v1, 10, v13
    v_lshl_add_u32 v1, v12, 4, v1
L_wf_21:
    ds_read_b32 v15, v14 offset:0
    s_waitcnt lgkmcnt(0)
    v_readfirstlane_b32 s33, v15
    s_nop 0
    s_cmp_ge_u32 s33, 5
    s_cbranch_scc1 L_wfd_22
    s_sleep 1
    s_sub_u32 s32, s32, 1
    s_cbranch_scc1 L_exit
    s_branch L_wf_21
L_wfd_22:
    buffer_load_dwordx4 v[32:35], v11, s[36:39], s58 offen
    s_add_u32 m0, s57, 0
    s_add_u32 s49, s48, 0
    buffer_load_dwordx4 v2, s[40:43], s49 offen nt lds
    s_add_u32 m0, s57, 1024
    s_add_u32 s49, s48, 8192
    buffer_load_dwordx4 v3, s[40:43], s49 offen nt lds
    s_add_u32 m0, s57, 2048
    s_add_u32 s49, s48, 16384
    buffer_load_dwordx4 v2, s[40:43], s49 offen nt lds
    s_add_u32 m0, s57, 3072
    s_add_u32 s49, s48, 24576
    buffer_load_dwordx4 v3, s[40:43], s49 offen nt lds
    s_add_u32 m0, s57, 4096
    s_add_u32 s49, s48, 32768
    buffer_load_dwordx4 v2, s[40:43], s49 offen nt lds
    s_add_u32 m0, s57, 5120
    s_add_u32 s49, s48, 40960
    buffer_load_dwordx4 v3, s[40:43], s49 offen nt lds
    s_add_u32 m0, s57, 6144
    s_add_u32 s49, s48, 49152
    buffer_load_dwordx4 v2, s[40:43], s49 offen nt lds
    s_add_u32 m0, s57, 7168
    s_add_u32 s49, s48, 57344
    buffer_load_dwordx4 v3, s[40:43], s49 offen nt lds
    s_waitcnt vmcnt(6)
    s_add_u32 m0, s57, 8192
    s_add_u32 s49, s48, 65536
    buffer_load_dwordx4 v2, s[40:43], s49 offen nt lds
    s_add_u32 m0, s57, 9216
    s_add_u32 s49, s48, 73728
    buffer_load_dwordx4 v3, s[40:43], s49 offen nt lds
    s_waitcnt vmcnt(6)
    s_add_u32 m0, s57, 10240
    s_add_u32 s49, s48, 81920
    buffer_load_dwordx4 v2, s[40:43], s49 offen nt lds
    s_add_u32 m0, s57, 11264
    s_add_u32 s49, s48, 90112
    buffer_load_dwordx4 v3, s[40:43], s49 offen nt lds
    s_waitcnt vmcnt(6)
    s_add_u32 m0, s57, 12288
    s_add_u32 s49, s48, 98304
    buffer_load_dwordx4 v2, s[40:43], s49 offen nt lds
    s_add_u32 m0, s57, 13312
    s_add_u32 s49, s48, 106496
    buffer_load_dwordx4 v3, s[40:43], s49 offen nt lds
    s_waitcnt vmcnt(6)
    s_add_u32 m0, s57, 14336
    s_add_u32 s49, s48, 114688
    buffer_load_dwordx4 v2, s[40:43], s49 offen nt lds
    s_add_u32 m0, s57, 15360
    s_add_u32 s49, s48, 122880
    buffer_load_dwordx4 v3, s[40:43], s49 offen nt lds
    s_waitcnt vmcnt(16)
L_Tsp:
    v_xor_b32 v33, s96, v33
    v_xor_b32 v35, s96, v35
    v_or_b32 v15, v33, v35
    v_cmp_ne_u32 vcc, 0, v15
    s_cbranch_vccz L_Tsq
    s_sleep 4
    s_sub_u32 s32, s32, 1
    s_cbranch_scc1 L_exit
    buffer_load_dwordx4 v[32:35], v11, s[36:39], s58 offen sc1
    s_waitcnt vmcnt(0)
    s_branch L_Tsp
L_Tsq:
    v_and_b32 v32, 0xffff0000, v32
    v_mov_b32 v8, v32
    s_nop 1
    v_max_f32_dpp v8, v8, v8 row_ror:4 row_mask:0xf bank_mask:0xf
    s_nop 1
    v_max_f32_dpp v8, v8, v8 row_ror:8 row_mask:0xf bank_mask:0xf
    v_mov_b32 v10, v8
    s_nop 1
    v_permlane16_swap_b32 v8, v10
    v_max_f32 v8, v8, v10
    v_sub_f32 v32, v32, v8
    v_mul_f32 v32, s59, v32
    v_exp_f32 v32, v32
    s_nop 0
    v_mul_f32 v9, v32, v34
    s_nop 1
    v_add_f32_dpp v9, v9, v9 row_ror:4 row_mask:0xf bank_mask:0xf
    s_nop 1
    v_add_f32_dpp v9, v9, v9 row_ror:8 row_mask:0xf bank_mask:0xf
    v_mov_b32 v10, v9
    s_nop 1
    v_permlane16_swap_b32 v9, v10
    v_add_f32 v9, v9, v10
    v_rcp_f32 v9, v9
    s_nop 0
    v_mul_f32 v32, v32, v9
    s_nop 1
    v_mov_b32_dpp v48, v32 row_newbcast:0 row_mask:0xf bank_mask:0xf
    v_mov_b32_dpp v49, v32 row_newbcast:4 row_mask:0xf bank_mask:0xf
    v_mov_b32_dpp v50, v32 row_newbcast:8 row_mask:0xf bank_mask:0xf
    v_mov_b32_dpp v51, v32 row_newbcast:12 row_mask:0xf bank_mask:0xf
    v_lshlrev_b32 v52, 16, v56
    v_and_b32 v53, 0xffff0000, v56
    v_lshlrev_b32 v54, 16, v57
    v_and_b32 v55, 0xffff0000, v57
    s_waitcnt vmcnt(12)
    ds_read_b64_tr_b16 v[64:65], v4 offset:0
    ds_read_b64_tr_b16 v[66:67], v4 offset:512
    ds_read_b64_tr_b16 v[68:69], v5 offset:0
    ds_read_b64_tr_b16 v[70:71], v5 offset:512
    ds_read_b64_tr_b16 v[72:73], v6 offset:0
    ds_read_b64_tr_b16 v[74:75], v6 offset:512
    ds_read_b64_tr_b16 v[76:77], v7 offset:0
    ds_read_b64_tr_b16 v[78:79], v7 offset:512
    s_waitcnt vmcnt(8)
    s_waitcnt lgkmcnt(0)
    ds_read_b64_tr_b16 v[80:81], v4 offset:4096
    ds_read_b64_tr_b16 v[82:83], v4 offset:4608
    ds_read_b64_tr_b16 v[84:85], v5 offset:4096
    ds_read_b64_tr_b16 v[86:87], v5 offset:4608
    ds_read_b64_tr_b16 v[88:89], v6 offset:4096
    ds_read_b64_tr_b16 v[90:91], v6 offset:4608
    ds_read_b64_tr_b16 v[92:93], v7 offset:4096
    ds_read_b64_tr_b16 v[94:95], v7 offset:4608
    s_waitcnt vmcnt(4)
    s_waitcnt lgkmcnt(0)
    ds_read_b64_tr_b16 v[96:97], v4 offset:8192
    ds_read_b64_tr_b16 v[98:99], v4 offset:8704
    ds_read_b64_tr_b16 v[100:101], v5 offset:8192
    ds_read_b64_tr_b16 v[102:103], v5 offset:8704
    ds_read_b64_tr_b16 v[104:105], v6 offset:8192
    ds_read_b64_tr_b16 v[106:107], v6 offset:8704
    ds_read_b64_tr_b16 v[108:109], v7 offset:8192
    ds_read_b64_tr_b16 v[110:111], v7 offset:8704
    s_waitcnt vmcnt(0)
    s_add_u32 m0, s56, 0
    s_nop 0
    buffer_load_dwordx4 v252, s[36:39], s60 offen sc1 lds
    s_add_u32 m0, s56, 1024
    s_nop 0
    buffer_load_dwordx4 v253, s[36:39], s61 offen sc1 lds
    s_add_u32 m0, s56, 2048
    s_nop 0
    buffer_load_dwordx4 v254, s[36:39], s54 offen sc1 lds
    s_add_u32 m0, s56, 3072
    s_nop 0
    buffer_load_dwordx4 v255, s[36:39], s55 offen sc1 lds
    s_waitcnt lgkmcnt(0)
    ds_read_b64_tr_b16 v[112:113], v4 offset:12288
    ds_read_b64_tr_b16 v[114:115], v4 offset:12800
    ds_read_b64_tr_b16 v[116:117], v5 offset:12288
    ds_read_b64_tr_b16 v[118:119], v5 offset:12800
    ds_read_b64_tr_b16 v[120:121], v6 offset:12288
    ds_read_b64_tr_b16 v[122:123], v6 offset:12800
    ds_read_b64_tr_b16 v[124:125], v7 offset:12288
    ds_read_b64_tr_b16 v[126:127], v7 offset:12800
    s_waitcnt vmcnt(0)
    ds_read_b128 v[16:19], v60
    ds_read_b128 v[20:23], v61
    ds_read_b128 v[24:27], v62
    ds_read_b128 v[28:31], v63
    s_waitcnt lgkmcnt(0)
    s_branch L_gc_24
L_gp_23:
    buffer_load_dwordx4 v[16:19], v1, s[36:39], s60 offen offset:0 sc1
    buffer_load_dwordx4 v[20:23], v1, s[36:39], s60 offen offset:64 sc1
    buffer_load_dwordx4 v[24:27], v1, s[36:39], s60 offen offset:128 sc1
    buffer_load_dwordx4 v[28:31], v1, s[36:39], s60 offen offset:192 sc1
    s_mov_b64 exec, -1
    s_waitcnt vmcnt(0)
L_gc_24:
    v_mfma_f32_16x16x32_bf16 v[32:35], v[16:19], v[64:67], 0
    v_max_u32 v15, v16, v17
    v_max3_u32 v15, v15, v18, v19
    v_mfma_f32_16x16x32_bf16 v[32:35], v[20:23], v[80:83], v[32:35]
    v_max3_u32 v15, v15, v20, v21
    v_max3_u32 v15, v15, v22, v23
    v_mfma_f32_16x16x32_bf16 v[32:35], v[24:27], v[96:99], v[32:35]
    v_max3_u32 v15, v15, v24, v25
    v_max3_u32 v15, v15, v26, v27
    v_mfma_f32_16x16x32_bf16 v[32:35], v[28:31], v[112:115], v[32:35]
    v_max3_u32 v15, v15, v28, v29
    v_max3_u32 v15, v15, v30, v31
    v_cmp_eq_u32 vcc, -1, v15
    v_mfma_f32_16x16x32_bf16 v[36:39], v[16:19], v[68:71], 0
    s_cbranch_vccz L_gd_25
    s_sub_u32 s32, s32, 1
    s_cbranch_scc1 L_exit
    s_mov_b64 exec, vcc
    s_branch L_gp_23
L_gd_25:
    v_mfma_f32_16x16x32_bf16 v[36:39], v[20:23], v[84:87], v[36:39]
    v_mfma_f32_16x16x32_bf16 v[36:39], v[24:27], v[100:103], v[36:39]
    v_mfma_f32_16x16x32_bf16 v[36:39], v[28:31], v[116:119], v[36:39]
    v_mfma_f32_16x16x32_bf16 v[40:43], v[16:19], v[72:75], 0
    v_mfma_f32_16x16x32_bf16 v[40:43], v[20:23], v[88:91], v[40:43]
    v_mfma_f32_16x16x32_bf16 v[40:43], v[24:27], v[104:107], v[40:43]
    v_mfma_f32_16x16x32_bf16 v[40:43], v[28:31], v[120:123], v[40:43]
    v_mfma_f32_16x16x32_bf16 v[44:47], v[16:19], v[76:79], 0
    v_mul_f32 v8, v32, v48
    s_nop 1
    v_mul_f32 v9, v36, v48
    v_mfma_f32_16x16x32_bf16 v[44:47], v[20:23], v[92:95], v[44:47]
    v_fmac_f32 v8, v33, v49
    v_fmac_f32 v9, v37, v49
    v_mfma_f32_16x16x32_bf16 v[44:47], v[24:27], v[108:111], v[44:47]
    v_fmac_f32 v8, v34, v50
    v_fmac_f32 v9, v38, v50
    v_mfma_f32_16x16x32_bf16 v[44:47], v[28:31], v[124:127], v[44:47]
    v_fmac_f32 v8, v35, v51
    v_fmac_f32 v9, v39, v51
    ds_write2_b32 v247, v8, v9 offset0:0 offset1:16
    v_mul_f32 v10, v40, v48
    v_fmac_f32 v10, v41, v49
    v_fmac_f32 v10, v42, v50
    v_fmac_f32 v10, v43, v51
    s_nop 0
    v_mul_f32 v11, v44, v48
    v_fmac_f32 v11, v45, v49
    v_fmac_f32 v11, v46, v50
    v_fmac_f32 v11, v47, v51
    ds_write2_b32 v247, v10, v11 offset0:32 offset1:48
    s_waitcnt lgkmcnt(0)
    s_barrier
    s_cmp_lg_u32 s31, 3
    s_cbranch_scc1 L_Wd
    ds_read_b128 v[32:35], v58 offset:0
    ds_read_b128 v[36:39], v58 offset:1280
    ds_read_b128 v[40:43], v58 offset:2560
    ds_read_b128 v[44:47], v58 offset:3840
    s_waitcnt lgkmcnt(2)
    v_pk_add_f32 v[32:33], v[32:33], v[36:37]
    v_pk_add_f32 v[34:35], v[34:35], v[38:39]
    s_waitcnt lgkmcnt(0)
    v_pk_add_f32 v[40:41], v[40:41], v[44:45]
    v_pk_add_f32 v[42:43], v[42:43], v[46:47]
    v_pk_add_f32 v[32:33], v[32:33], v[40:41]
    v_pk_add_f32 v[34:35], v[34:35], v[42:43]
    s_nop 0
    v_add_f32_dpp v32, v32, v32 quad_perm:[1,0,3,2] row_mask:0xf bank_mask:0xf
    v_add_f32_dpp v33, v33, v33 quad_perm:[1,0,3,2] row_mask:0xf bank_mask:0xf
    v_add_f32_dpp v34, v34, v34 quad_perm:[1,0,3,2] row_mask:0xf bank_mask:0xf
    v_add_f32_dpp v35, v35, v35 quad_perm:[1,0,3,2] row_mask:0xf bank_mask:0xf
    v_pk_add_f32 v[32:33], v[32:33], v[52:53]
    v_pk_add_f32 v[34:35], v[34:35], v[54:55]
    v_cvt_pk_bf16_f32 v36, v32, v33
    v_cvt_pk_bf16_f32 v37, v34, v35
    v_min_u32 v36, -2, v36
    v_min_u32 v37, -2, v37
    s_nop 0
    v_mov_b32_dpp v38, v36 quad_perm:[2,3,2,3] row_mask:0xf bank_mask:0xf
    s_nop 0
    v_mov_b32_dpp v39, v37 quad_perm:[2,3,2,3] row_mask:0xf bank_mask:0xf
    s_mov_b32 exec_lo, 0x11111111
    s_mov_b32 exec_hi, 0x11111111
    buffer_store_dwordx4 v[36:39], v59, s[36:39], s51 offen sc1
    buffer_store_dwordx4 v[36:39], v59, s[36:39], s11 offen
    s_barrier
    s_branch L_exit
L_Wd:
    s_cmp_ge_u32 s31, 2
    s_cbranch_scc1 L_Wg
    s_lshl_b32 s48, s30, 2
    s_add_u32 s48, s48, s62
    s_add_u32 s48, s48, s31
    s_lshl_b32 s49, s28, 5
    s_add_u32 s48, s48, s49
    s_mul_i32 s48, s48, 7168
    v_min_u32 v1, 55, v0
    v_lshl_add_u32 v1, v1, 7, s48
    s_barrier
    global_load_dword v16, v1, s[20:21] sc1 nt
    global_load_dword v16, v1, s[20:21] sc1
    s_branch L_exit
L_Wg:
    s_lshl_b32 s48, s30, 1
    s_lshr_b32 s49, s29, 1
    s_add_u32 s48, s48, s49
    s_lshr_b32 s49, s48, 2
    s_lshl_b32 s49, s49, 7
    s_and_b32 s48, s48, 3
    s_lshl_b32 s48, s48, 3
    s_add_u32 s48, s48, s49
    s_add_u32 s48, s48, 96
    s_mul_i32 s48, s48, 3584
    s_mul_i32 s49, s28, 448
    s_and_b32 s49, s49, 0xffffff80
    s_add_u32 s48, s48, s49
    v_bfe_u32 v2, v0, 2, 3
    v_mul_u32_u24 v2, 3584, v2
    v_and_b32 v3, 3, v0
    v_lshl_add_u32 v2, v3, 7, v2
    v_add_u32 v2, s48, v2
    v_mov_b32 v3, 0
    v_lshl_add_u64 v[4:5], v[2:3], 0, s[16:17]
    s_mov_b32 exec_lo, 0
    v_lshl_add_u64 v[4:5], v[2:3], 0, s[18:19]
    s_mov_b64 exec, -1
    s_barrier
    s_mov_b32 s48, -114688
    s_mov_b32 s49, -1
    v_lshl_add_u64 v[6:7], v[4:5], 0, s[48:49]
    global_load_dword v16, v[6:7], off sc1 nt
    global_load_dword v16, v[4:5], off sc1 nt
    global_load_dword v16, v[6:7], off sc1
    global_load_dword v16, v[4:5], off sc1
    s_branch L_exit
L_F:
    s_add_u32 s30, s97, s28
    s_add_u32 s30, s30, 5
    s_mul_i32 s49, s30, 37
    s_lshr_b32 s49, s49, 8
    s_mul_i32 s49, s49, 7
    s_sub_u32 s30, s30, s49
    s_mul_i32 s61, s28, 7
    s_add_u32 s61, s61, s30
    s_add_u32 s55, s52, s53
    s_lshr_b32 s54, s61, 2
    s_mul_i32 s54, s54, 278528
    s_and_b32 s49, s61, 3
    s_lshl_b32 s49, s49, 10
    s_add_u32 s54, s54, s49
    s_add_u32 s54, s54, s55
    s_add_u32 s55, s55, 3899392
    s_mov_b32 s40, s20
    s_mov_b32 s41, s21
    s_mov_b32 s42, 0x1c0000
    s_mov_b32 s43, 0x20000
    s_mov_b32 s44, s22
    s_mov_b32 s45, s23
    s_mov_b32 s46, 0x1000
    s_mov_b32 s47, 0x20000
    s_lshl_b32 s14, s61, 15
    s_add_u32 s14, s14, s53
    s_add_u32 s15, s14, 16384
    s_lshl_b32 s11, s100, 2
    s_add_u32 s11, s11, s62
    s_lshl_b32 s11, s11, 12
    s_add_u32 s11, s11, 4456448
    s_lshr_b32 s8, s100, 2
    s_mul_i32 s9, s8, 278528
    s_and_b32 s13, s100, 3
    s_lshl_b32 s49, s13, 10
    s_add_u32 s9, s9, s49
    s_add_u32 s9, s9, s55
    s_add_u32 s11, s11, s53
    s_sub_u32 s11, s11, s9
    s_lshl_b32 s13, s13, 4
    s_add_u32 s9, s63, 32768
    s_and_b32 s12, s28, 1
    s_lshl_b32 s12, s12, 3
    s_lshl_b32 s12, 0x00ff00ff, s12
    s_lshr_b32 s49, s28, 1
    s_cmp_eq_u32 s49, s31
    s_cselect_b32 s12, s12, 0
    v_lshrrev_b32 v228, 2, v0
    v_lshlrev_b32 v228, 6, v228
    s_lshl_b32 s6, 0x01010101, s100
    s_mov_b32 s7, s6
    v_mul_u32_u24 v10, 3584, v9
    v_and_b32 v11, 3, v8
    v_lshl_add_u32 v10, v11, 4, v10
    s_mul_i32 s49, s31, 458752
    s_lshl_b32 s50, s61, 6
    s_add_u32 s49, s49, s50
    v_add_u32 v10, s49, v10
    v_mov_b32 v11, 0
    v_lshl_add_u64 v[224:225], v[10:11], 0, s[16:17]
    v_lshl_add_u64 v[226:227], v[10:11], 0, s[18:19]
    s_mov_b32 exec_lo, 0xf0f0f0f0
    s_mov_b32 exec_hi, 0xf0f0f0f0
    v_lshl_add_u64 v[224:225], v[10:11], 0, s[18:19]
    v_lshl_add_u64 v[226:227], v[10:11], 0, s[16:17]
    s_mov_b64 exec, -1
    s_mov_b32 s98, 28672
    s_mov_b32 s99, 0
    v_lshl_add_u64 v[226:227], v[226:227], 0, s[98:99]
    s_mov_b32 s98, 57344
    s_mul_i32 s50, s31, 320
    s_add_u32 s50, s50, 147456
    v_lshl_add_u32 v247, v13, 4, s50
    v_mov_b32 v240, 0x3f803f80
    v_mov_b32 v241, 0x3f803f80
    v_mov_b32 v242, 0x3f803f80
    v_mov_b32 v243, 0x3f803f80
    v_lshrrev_b32 v229, 5, v0
    v_mul_u32_u24 v229, 557056, v229
    v_bfe_u32 v1, v0, 2, 3
    v_lshl_add_u32 v229, v1, 6, v229
    s_lshl_b32 s58, s31, 2
    s_lshr_b32 s50, s29, 1
    s_add_u32 s58, s58, s50
    s_mul_i32 s58, s58, 278528
    s_add_u32 s58, s58, 32772
    v_bfe_u32 v1, v0, 2, 1
    v_mul_u32_u24 v1, 278528, v1
    v_and_b32 v3, 3, v0
    v_lshl_add_u32 v1, v3, 10, v1
    v_bfe_u32 v3, v0, 3, 1
    v_lshl_add_u32 v1, v3, 12, v1
    v_lshl_add_u32 v1, v12, 4, v1
    s_add_u32 s60, s55, 278528
    s_add_u32 s63, s55, 4096
    s_add_u32 s51, s55, 282624
    s_mul_i32 s50, s31, 1280
    s_add_u32 s50, s50, 142336
    v_lshrrev_b32 v2, 1, v12
    v_mul_u32_u24 v2, 320, v2
    v_lshl_add_u32 v2, v13, 4, v2
    v_and_b32 v3, 1, v12
    v_lshl_add_u32 v2, v3, 3, v2
    v_add_u32 v2, s50, v2
    v_and_b32 v8, 3, v0
    v_lshl_add_u32 v8, v12, 2, v8
    v_lshlrev_b32 v8, 4, v8
    v_bfe_u32 v9, v0, 3, 1
    v_bfe_u32 v10, v0, 2, 1
    v_mul_u32_u24 v230, 640, v9
    v_add_u32 v230, v230, v8
    v_add_u32 v230, 147456, v230
    v_mul_u32_u24 v231, 2560, v9
    v_mul_u32_u24 v3, 320, v10
    v_add3_u32 v231, v231, v3, v8
    v_add_u32 v231, 142336, v231
    v_lshlrev_b32 v3, 5, v10
    v_add_u32 v3, 148736, v3
    s_lshl_b32 s50, s31, 2
    s_add_u32 s50, s50, 148736
    v_lshl_add_u32 v59, v12, 4, s50
    s_lshl_b32 s50, s97, 5
    s_lshl_b32 s100, s28, 7
    s_add_u32 s100, s100, s50
    s_lshr_b32 s50, s31, 1
    s_add_u32 s101, s62, s50
    s_lshl_b32 s101, s101, 10
    s_add_u32 s101, s101, s100
    s_lshl_b32 s50, s50, 12
    s_add_u32 s100, s100, s50
    s_add_u32 s100, s100, s52
    s_add_u32 s10, s100, 2228224
    v_lshrrev_b32 v244, 3, v0
    v_mul_u32_u24 v244, 278528, v244
    v_bfe_u32 v8, v0, 1, 2
    v_lshl_add_u32 v244, v8, 10, v244
    v_and_b32 v8, 1, v0
    v_lshl_add_u32 v244, v8, 4, v244
    v_and_b32 v245, 7, v0
    v_lshlrev_b32 v245, 1, v245
    v_lshrrev_b32 v8, 5, v0
    v_lshl_add_u32 v245, v8, 4, v245
    v_lshrrev_b32 v8, 1, v13
    v_and_b32 v9, 1, v0
    v_lshlrev_b32 v9, 4, v9
    s_mov_b32 s50, 0x3f80
    v_lshlrev_b32 v9, v9, s50
    v_cmp_eq_u32 vcc, 0, v8
    s_nop 1
    v_cndmask_b32 v248, 0, v9, vcc
    v_cmp_eq_u32 vcc, 1, v8
    s_nop 1
    v_cndmask_b32 v249, 0, v9, vcc
    v_cmp_eq_u32 vcc, 2, v8
    s_nop 1
    v_cndmask_b32 v250, 0, v9, vcc
    v_cmp_eq_u32 vcc, 3, v8
    s_nop 1
    v_cndmask_b32 v251, 0, v9, vcc
L_wf_26:
    ds_read_b32 v15, v14 offset:0
    s_waitcnt lgkmcnt(0)
    v_readfirstlane_b32 s33, v15
    s_nop 0
    s_cmp_ge_u32 s33, 5
    s_cbranch_scc1 L_wfd_27
    s_sleep 1
    s_sub_u32 s32, s32, 1
    s_cbranch_scc1 L_exit
    s_branch L_wf_26
L_wfd_27:
    buffer_load_dword v58, v229, s[36:39], s58 offen
    buffer_load_dwordx2 v[56:57], v228, s[36:39], s9 offen
    s_add_u32 m0, s57, 0
    s_nop 0
    global_load_lds_dwordx4 v[224:225], off nt
    v_lshl_add_u64 v[224:225], v[224:225], 0, s[98:99]
    s_add_u32 m0, s57, 1024
    s_nop 0
    global_load_lds_dwordx4 v[226:227], off nt
    v_lshl_add_u64 v[226:227], v[226:227], 0, s[98:99]
    s_add_u32 m0, s57, 2048
    s_nop 0
    global_load_lds_dwordx4 v[224:225], off nt
    v_lshl_add_u64 v[224:225], v[224:225], 0, s[98:99]
L_wf_28:
    ds_read_b32 v15, v14 offset:0
    s_waitcnt lgkmcnt(0)
    v_readfirstlane_b32 s33, v15
    s_nop 0
    s_cmp_ge_u32 s33, 6
    s_cbranch_scc1 L_wfd_29
    s_sleep 1
    s_sub_u32 s32, s32, 1
    s_cbranch_scc1 L_exit
    s_branch L_wf_28
L_wfd_29:
    s_add_u32 m0, s57, 3072
    s_nop 0
    global_load_lds_dwordx4 v[226:227], off nt
    v_lshl_add_u64 v[226:227], v[226:227], 0, s[98:99]
    s_add_u32 m0, s57, 4096
    s_nop 0
    global_load_lds_dwordx4 v[224:225], off nt
    v_lshl_add_u64 v[224:225], v[224:225], 0, s[98:99]
    s_add_u32 m0, s57, 5120
    s_nop 0
    global_load_lds_dwordx4 v[226:227], off nt
    v_lshl_add_u64 v[226:227], v[226:227], 0, s[98:99]
    s_add_u32 m0, s57, 6144
    s_nop 0
    global_load_lds_dwordx4 v[224:225], off nt
    v_lshl_add_u64 v[224:225], v[224:225], 0, s[98:99]
    s_add_u32 m0, s57, 7168
    s_nop 0
    global_load_lds_dwordx4 v[226:227], off nt
    v_lshl_add_u64 v[226:227], v[226:227], 0, s[98:99]
    s_add_u32 m0, s57, 8192
    s_nop 0
    global_load_lds_dwordx4 v[224:225], off nt
    v_lshl_add_u64 v[224:225], v[224:225], 0, s[98:99]
    s_add_u32 m0, s57, 9216
    s_nop 0
    global_load_lds_dwordx4 v[226:227], off nt
    v_lshl_add_u64 v[226:227], v[226:227], 0, s[98:99]
    s_add_u32 m0, s57, 10240
    s_nop 0
    global_load_lds_dwordx4 v[224:225], off nt
    v_lshl_add_u64 v[224:225], v[224:225], 0, s[98:99]
    s_add_u32 m0, s57, 11264
    s_nop 0
    global_load_lds_dwordx4 v[226:227], off nt
    v_lshl_add_u64 v[226:227], v[226:227], 0, s[98:99]
    s_add_u32 m0, s57, 12288
    s_nop 0
    global_load_lds_dwordx4 v[224:225], off nt
    v_lshl_add_u64 v[224:225], v[224:225], 0, s[98:99]
    s_add_u32 m0, s57, 13312
    s_nop 0
    global_load_lds_dwordx4 v[226:227], off nt
    v_lshl_add_u64 v[226:227], v[226:227], 0, s[98:99]
    s_add_u32 m0, s57, 14336
    s_nop 0
    global_load_lds_dwordx4 v[224:225], off nt
    s_add_u32 m0, s57, 15360
    s_nop 0
    global_load_lds_dwordx4 v[226:227], off nt
    s_waitcnt vmcnt(16)
L_Fcp:
    v_xor_b32 v57, s96, v57
    v_xor_b32 v58, s96, v58
    v_or_b32 v15, v57, v58
    v_cmp_ne_u32 vcc, 0, v15
    s_cbranch_vccz L_Fcq
    s_sleep 4
    s_sub_u32 s32, s32, 1
    s_cbranch_scc1 L_exit
    buffer_load_dword v58, v229, s[36:39], s58 offen sc1
    buffer_load_dwordx2 v[56:57], v228, s[36:39], s9 offen sc1
    s_waitcnt vmcnt(0)
    s_branch L_Fcp
L_Fcq:
    s_getreg_b32 s33, hwreg(HW_REG_XCC_ID, 0, 4)
    v_and_b32 v56, 0xffff, v56
    v_cmp_ne_u32 vcc, s33, v56
    s_cbranch_vccz L_Fl
    s_mov_b32 s12, 0
    s_branch L_Fn
L_Fl:
    s_mov_b64 exec, s[6:7]
    v_add_u32 v1, s11, v1
    s_lshl_b64 exec, 0xffff, s13
    s_cmp_eq_u32 s8, 0
    s_cselect_b32 s9, s11, 0
    s_cselect_b32 s11, 0, s11
    v_add_u32 v252, s9, v252
    v_add_u32 v254, s9, v254
    v_add_u32 v253, s11, v253
    v_add_u32 v255, s11, v255
    s_mov_b64 exec, -1
L_Fn:
    s_waitcnt vmcnt(12)
    s_waitcnt lgkmcnt(0)
    ds_read_b64_tr_b16 v[64:65], v4 offset:0
    ds_read_b64_tr_b16 v[66:67], v4 offset:512
    ds_read_b64_tr_b16 v[68:69], v5 offset:0
    ds_read_b64_tr_b16 v[70:71], v5 offset:512
    ds_read_b64_tr_b16 v[72:73], v6 offset:0
    ds_read_b64_tr_b16 v[74:75], v6 offset:512
    ds_read_b64_tr_b16 v[76:77], v7 offset:0
    ds_read_b64_tr_b16 v[78:79], v7 offset:512
    s_waitcnt vmcnt(8)
    s_waitcnt lgkmcnt(0)
    ds_read_b64_tr_b16 v[80:81], v4 offset:4096
    ds_read_b64_tr_b16 v[82:83], v4 offset:4608
    ds_read_b64_tr_b16 v[84:85], v5 offset:4096
    ds_read_b64_tr_b16 v[86:87], v5 offset:4608
    ds_read_b64_tr_b16 v[88:89], v6 offset:4096
    ds_read_b64_tr_b16 v[90:91], v6 offset:4608
    ds_read_b64_tr_b16 v[92:93], v7 offset:4096
    ds_read_b64_tr_b16 v[94:95], v7 offset:4608
    v_mfma_f32_16x16x32_bf16 v[32:35], v[240:243], v[64:67], 0
    v_mfma_f32_16x16x32_bf16 v[36:39], v[240:243], v[68:71], 0
    v_mfma_f32_16x16x32_bf16 v[40:43], v[240:243], v[72:75], 0
    v_mfma_f32_16x16x32_bf16 v[44:47], v[240:243], v[76:79], 0
    s_waitcnt vmcnt(4)
    s_waitcnt lgkmcnt(0)
    ds_read_b64_tr_b16 v[96:97], v4 offset:8192
    ds_read_b64_tr_b16 v[98:99], v4 offset:8704
    ds_read_b64_tr_b16 v[100:101], v5 offset:8192
    ds_read_b64_tr_b16 v[102:103], v5 offset:8704
    ds_read_b64_tr_b16 v[104:105], v6 offset:8192
    ds_read_b64_tr_b16 v[106:107], v6 offset:8704
    ds_read_b64_tr_b16 v[108:109], v7 offset:8192
    ds_read_b64_tr_b16 v[110:111], v7 offset:8704
    v_mfma_f32_16x16x32_bf16 v[32:35], v[240:243], v[80:83], v[32:35]
    v_mfma_f32_16x16x32_bf16 v[36:39], v[240:243], v[84:87], v[36:39]
    v_mfma_f32_16x16x32_bf16 v[40:43], v[240:243], v[88:91], v[40:43]
    v_mfma_f32_16x16x32_bf16 v[44:47], v[240:243], v[92:95], v[44:47]
    s_waitcnt vmcnt(0)
    s_barrier
    s_add_u32 m0, s56, 0
    s_nop 0
    buffer_load_dwordx4 v252, s[36:39], s55 offen sc1 lds
    s_add_u32 m0, s56, 1024
    s_nop 0
    buffer_load_dwordx4 v253, s[36:39], s60 offen sc1 lds
    s_add_u32 m0, s56, 2048
    s_nop 0
    buffer_load_dwordx4 v254, s[36:39], s63 offen sc1 lds
    s_add_u32 m0, s56, 3072
    s_nop 0
    buffer_load_dwordx4 v255, s[36:39], s51 offen sc1 lds
    s_waitcnt lgkmcnt(0)
    ds_read_b64_tr_b16 v[112:113], v4 offset:12288
    ds_read_b64_tr_b16 v[114:115], v4 offset:12800
    ds_read_b64_tr_b16 v[116:117], v5 offset:12288
    ds_read_b64_tr_b16 v[118:119], v5 offset:12800
    ds_read_b64_tr_b16 v[120:121], v6 offset:12288
    ds_read_b64_tr_b16 v[122:123], v6 offset:12800
    ds_read_b64_tr_b16 v[124:125], v7 offset:12288
    ds_read_b64_tr_b16 v[126:127], v7 offset:12800
    v_mfma_f32_16x16x32_bf16 v[32:35], v[240:243], v[96:99], v[32:35]
    v_mfma_f32_16x16x32_bf16 v[36:39], v[240:243], v[100:103], v[36:39]
    v_mfma_f32_16x16x32_bf16 v[40:43], v[240:243], v[104:107], v[40:43]
    v_mfma_f32_16x16x32_bf16 v[44:47], v[240:243], v[108:111], v[44:47]
    s_waitcnt lgkmcnt(0)
    v_mfma_f32_16x16x32_bf16 v[32:35], v[240:243], v[112:115], v[32:35]
    v_mfma_f32_16x16x32_bf16 v[36:39], v[240:243], v[116:119], v[36:39]
    v_mfma_f32_16x16x32_bf16 v[40:43], v[240:243], v[120:123], v[40:43]
    v_mfma_f32_16x16x32_bf16 v[44:47], v[240:243], v[124:127], v[44:47]
    s_nop 4
    v_mov_b32 v8, v32
    v_mov_b32 v9, v36
    v_mov_b32 v10, v40
    v_mov_b32 v11, v44
    s_mov_b64 exec, 0xffff
    ds_write_b128 v247, v[8:11]
    s_mov_b64 exec, -1
    s_waitcnt lgkmcnt(0)
    s_barrier
    ds_read_b128 v[224:227], v230
    ds_read_b128 v[8:11], v230 offset:320
    s_waitcnt lgkmcnt(0)
    v_pk_add_f32 v[224:225], v[224:225], v[8:9]
    v_pk_add_f32 v[226:227], v[226:227], v[10:11]
    s_waitcnt vmcnt(0)
    ds_read_b128 v[16:19], v60
    ds_read_b128 v[20:23], v61
    ds_read_b128 v[24:27], v62
    ds_read_b128 v[28:31], v63
    s_waitcnt lgkmcnt(0)
    s_branch L_gc_31
L_gp_30:
    buffer_load_dwordx4 v[16:19], v1, s[36:39], s55 offen offset:0 sc1
    buffer_load_dwordx4 v[20:23], v1, s[36:39], s55 offen offset:64 sc1
    buffer_load_dwordx4 v[24:27], v1, s[36:39], s55 offen offset:128 sc1
    buffer_load_dwordx4 v[28:31], v1, s[36:39], s55 offen offset:192 sc1
    s_mov_b64 exec, -1
    s_waitcnt vmcnt(0)
L_gc_31:
    v_mfma_f32_16x16x32_bf16 v[232:235], v[16:19], v[16:19], 0
    v_max_u32 v15, v16, v17
    v_max3_u32 v15, v15, v18, v19
    v_mfma_f32_16x16x32_bf16 v[232:235], v[20:23], v[20:23], v[232:235]
    v_max3_u32 v15, v15, v20, v21
    v_max3_u32 v15, v15, v22, v23
    v_mfma_f32_16x16x32_bf16 v[232:235], v[24:27], v[24:27], v[232:235]
    v_max3_u32 v15, v15, v24, v25
    v_max3_u32 v15, v15, v26, v27
    v_mfma_f32_16x16x32_bf16 v[232:235], v[28:31], v[28:31], v[232:235]
    v_max3_u32 v15, v15, v28, v29
    v_max3_u32 v15, v15, v30, v31
    v_cmp_eq_u32 vcc, -1, v15
    v_mfma_f32_16x16x32_bf16 v[236:239], v[16:19], v[240:243], 0
    s_cbranch_vccz L_gd_32
    s_sleep 1
    s_sub_u32 s32, s32, 1
    s_cbranch_scc1 L_exit
    s_mov_b64 exec, vcc
    s_branch L_gp_30
L_gd_32:
    buffer_load_dwordx4 v[192:195], v246, s[40:43], s14 offen offset:0 nt
    v_mfma_f32_16x16x32_bf16 v[236:239], v[20:23], v[240:243], v[236:239]
    buffer_load_dwordx4 v[196:199], v246, s[40:43], s15 offen offset:0 nt
    v_mfma_f32_16x16x32_bf16 v[236:239], v[24:27], v[240:243], v[236:239]
    buffer_load_dwordx4 v[200:203], v246, s[40:43], s14 offen offset:1024 nt
    v_mfma_f32_16x16x32_bf16 v[236:239], v[28:31], v[240:243], v[236:239]
    buffer_load_dwordx4 v[204:207], v246, s[40:43], s15 offen offset:1024 nt
    v_mfma_f32_16x16x32_bf16 v[32:35], v[16:19], v[64:67], 0
    buffer_load_dwordx4 v[208:211], v246, s[40:43], s14 offen offset:2048 nt
    v_mfma_f32_16x16x32_bf16 v[32:35], v[20:23], v[80:83], v[32:35]
    buffer_load_dwordx4 v[212:215], v246, s[40:43], s15 offen offset:2048 nt
    v_mfma_f32_16x16x32_bf16 v[32:35], v[24:27], v[96:99], v[32:35]
    buffer_load_dwordx4 v[216:219], v246, s[40:43], s14 offen offset:3072 nt
    v_mfma_f32_16x16x32_bf16 v[32:35], v[28:31], v[112:115], v[32:35]
    v_add_f32 v232, v232, v233
    v_add_f32 v234, v234, v235
    buffer_load_dwordx4 v[220:223], v246, s[40:43], s15 offen offset:3072 nt
    v_mfma_f32_16x16x32_bf16 v[36:39], v[16:19], v[68:71], 0
    v_add_f32 v232, v232, v234
    v_mfma_f32_16x16x32_bf16 v[36:39], v[20:23], v[84:87], v[36:39]
    v_mfma_f32_16x16x32_bf16 v[36:39], v[24:27], v[100:103], v[36:39]
    v_add_f32_dpp v232, v232, v232 quad_perm:[1,0,3,2] row_mask:0xf bank_mask:0xf
    v_add_f32 v236, v236, v237
    v_mfma_f32_16x16x32_bf16 v[36:39], v[28:31], v[116:119], v[36:39]
    v_add_f32_dpp v232, v232, v232 quad_perm:[2,3,0,1] row_mask:0xf bank_mask:0xf
    v_add_f32 v238, v238, v239
    v_mfma_f32_16x16x32_bf16 v[40:43], v[16:19], v[72:75], 0
    v_add_f32_dpp v232, v232, v232 row_half_mirror row_mask:0xf bank_mask:0xf
    v_add_f32 v236, v236, v238
    v_mfma_f32_16x16x32_bf16 v[40:43], v[20:23], v[88:91], v[40:43]
    v_mfma_f32_16x16x32_bf16 v[40:43], v[24:27], v[104:107], v[40:43]
    v_permlane16_swap_b32 v232, v236
    v_add_f32 v232, v232, v236
    v_mfma_f32_16x16x32_bf16 v[40:43], v[28:31], v[120:123], v[40:43]
    v_mfma_f32_16x16x32_bf16 v[44:47], v[16:19], v[76:79], 0
    v_add_f32 v8, v32, v33
    v_add_f32 v34, v34, v35
    v_add_f32 v8, v8, v34
    v_mfma_f32_16x16x32_bf16 v[44:47], v[20:23], v[92:95], v[44:47]
    v_mfma_f32_16x16x32_bf16 v[44:47], v[24:27], v[108:111], v[44:47]
    v_add_f32 v9, v36, v37
    v_add_f32 v38, v38, v39
    v_add_f32 v9, v9, v38
    v_mfma_f32_16x16x32_bf16 v[44:47], v[28:31], v[124:127], v[44:47]
    s_mov_b32 exec_lo, 0x00010001
    s_mov_b32 exec_hi, 0x01000100
    ds_write_b32 v59, v232
    s_mov_b64 exec, -1
    v_add_f32 v10, v40, v41
    v_add_f32 v42, v42, v43
    v_add_f32 v10, v10, v42
    s_nop 1
    v_permlane16_swap_b32 v8, v10
    v_add_f32 v8, v8, v10
    v_add_f32 v11, v44, v45
    v_add_f32 v46, v46, v47
    v_add_f32 v11, v11, v46
    s_nop 1
    v_permlane16_swap_b32 v9, v11
    v_add_f32 v9, v9, v11
    ds_write_b64 v2, v[8:9]
    s_waitcnt lgkmcnt(0)
    s_barrier
    ds_read_b128 v[48:51], v3
    ds_read_b128 v[52:55], v3 offset:16
    ds_read_b128 v[32:35], v231 offset:0
    ds_read_b128 v[36:39], v231 offset:1280
    s_waitcnt vmcnt(0)
    v_perm_b32 v128, v196, v192, s34
    v_perm_b32 v132, v196, v192, s35
    v_perm_b32 v136, v197, v193, s34
    v_perm_b32 v140, v197, v193, s35
    v_perm_b32 v144, v198, v194, s34
    v_perm_b32 v148, v198, v194, s35
    v_perm_b32 v152, v199, v195, s34
    v_perm_b32 v156, v199, v195, s35
    v_perm_b32 v129, v204, v200, s34
    v_perm_b32 v133, v204, v200, s35
    v_perm_b32 v137, v205, v201, s34
    v_perm_b32 v141, v205, v201, s35
    v_perm_b32 v145, v206, v202, s34
    v_perm_b32 v149, v206, v202, s35
    v_perm_b32 v153, v207, v203, s34
    v_perm_b32 v157, v207, v203, s35
    v_perm_b32 v130, v212, v208, s34
    v_perm_b32 v134, v212, v208, s35
    v_perm_b32 v138, v213, v209, s34
    v_perm_b32 v142, v213, v209, s35
    v_perm_b32 v146, v214, v210, s34
    v_perm_b32 v150, v214, v210, s35
    v_perm_b32 v154, v215, v211, s34
    v_perm_b32 v158, v215, v211, s35
    v_perm_b32 v131, v220, v216, s34
    v_perm_b32 v135, v220, v216, s35
    v_perm_b32 v139, v221, v217, s34
    v_perm_b32 v143, v221, v217, s35
    v_perm_b32 v147, v222, v218, s34
    v_perm_b32 v151, v222, v218, s35
    v_perm_b32 v155, v223, v219, s34
    v_perm_b32 v159, v223, v219, s35
    s_waitcnt lgkmcnt(2)
    v_pk_add_f32 v[48:49], v[48:49], v[50:51]
    v_pk_add_f32 v[52:53], v[52:53], v[54:55]
    v_add_f32 v48, v48, v49
    v_add_f32 v52, v52, v53
    v_mul_f32 v52, 0x3b000000, v52
    v_mul_f32 v48, 0x3b000000, v48
    v_fma_f32 v48, -v52, v52, v48
    v_max_f32 v48, 0, v48
    v_add_f32 v48, 0x3727c5ac, v48
    v_rsq_f32 v48, v48
    s_waitcnt lgkmcnt(0)
    v_pk_add_f32 v[32:33], v[32:33], v[36:37]
    v_pk_add_f32 v[34:35], v[34:35], v[38:39]
    v_fma_f32 v32, -v52, v224, v32
    v_fma_f32 v33, -v52, v225, v33
    v_fma_f32 v34, -v52, v226, v34
    v_fma_f32 v35, -v52, v227, v35
    v_mul_f32 v49, 0xbfb8aa3b, v48
    v_mul_f32 v48, v48, v48
    v_add_f32_dpp v32, v32, v32 row_ror:8 row_mask:0xf bank_mask:0xf
    v_add_f32_dpp v33, v33, v33 row_ror:8 row_mask:0xf bank_mask:0xf
    v_add_f32_dpp v34, v34, v34 row_ror:8 row_mask:0xf bank_mask:0xf
    v_add_f32_dpp v35, v35, v35 row_ror:8 row_mask:0xf bank_mask:0xf
    v_mul_f32 v36, v49, v32
    v_mul_f32 v37, v49, v33
    v_exp_f32 v36, v36
    v_exp_f32 v37, v37
    v_mul_f32 v32, v32, v48
    v_mul_f32 v33, v33, v48
    v_add_f32 v36, 1.0, v36
    v_add_f32 v37, 1.0, v37
    v_rcp_f32 v36, v36
    v_rcp_f32 v37, v37
    v_mul_f32 v32, v32, v34
    v_mul_f32 v33, v33, v35
    v_mul_f32 v32, v32, v36
    v_mul_f32 v33, v33, v37
    v_cvt_pk_bf16_f32 v20, v32, v33
    s_nop 1
    v_mov_b32_dpp v16, v20 quad_perm:[0,0,0,0] row_mask:0xf bank_mask:0xf
    v_mov_b32_dpp v17, v20 quad_perm:[1,1,1,1] row_mask:0xf bank_mask:0xf
    v_mov_b32_dpp v18, v20 quad_perm:[2,2,2,2] row_mask:0xf bank_mask:0xf
    v_mov_b32_dpp v19, v20 quad_perm:[3,3,3,3] row_mask:0xf bank_mask:0xf
    s_nop 1
    v_mfma_f32_16x16x32_bf16 v[64:67], v[16:19], v[128:131], 0
    v_mfma_f32_16x16x32_bf16 v[68:71], v[16:19], v[132:135], 0
    v_mfma_f32_16x16x32_bf16 v[72:75], v[16:19], v[136:139], 0
    v_mfma_f32_16x16x32_bf16 v[76:79], v[16:19], v[140:143], 0
    v_mfma_f32_16x16x32_bf16 v[80:83], v[16:19], v[144:147], 0
    v_mfma_f32_16x16x32_bf16 v[84:87], v[16:19], v[148:151], 0
    v_mfma_f32_16x16x32_bf16 v[88:91], v[16:19], v[152:155], 0
    v_mfma_f32_16x16x32_bf16 v[92:95], v[16:19], v[156:159], 0
    s_nop 1
    v_cvt_pk_bf16_f32 v8, v64, v68
    v_min_u32 v8, -2, v8
    v_cvt_pk_bf16_f32 v9, v72, v76
    v_min_u32 v9, -2, v9
    v_cvt_pk_bf16_f32 v10, v80, v84
    v_min_u32 v10, -2, v10
    v_cvt_pk_bf16_f32 v11, v88, v92
    v_min_u32 v11, -2, v11
    s_mov_b32 exec_hi, 0
    s_andn2_b32 exec_lo, -1, s12
    buffer_store_dwordx4 v[8:11], v246, s[36:39], s54 offen sc1
    s_and_b32 exec_lo, s12, s12
    s_cbranch_scc0 L_Fm
    buffer_store_dwordx4 v[8:11], v246, s[36:39], s54 offen
L_Fm:
    s_mov_b64 exec, -1
    s_cmp_ge_u32 s97, 4
    s_cbranch_scc1 L_exit
    s_bitcmp1_b32 s31, 0
    s_cbranch_scc1 L_Eu
    s_waitcnt vmcnt(0)
L_Gp:
    buffer_load_dwordx4 v[16:19], v244, s[36:39], s100 offen sc1
    buffer_load_dwordx4 v[20:23], v244, s[36:39], s10 offen sc1
    s_mov_b64 exec, -1
    s_waitcnt vmcnt(0)
    v_mfma_f32_16x16x32_bf16 v[24:27], v[16:19], v[248:251], 0
    v_mfma_f32_16x16x32_bf16 v[24:27], v[20:23], v[248:251], v[24:27]
    v_max_u32 v15, v16, v17
    v_max3_u32 v15, v15, v18, v19
    v_max3_u32 v15, v15, v20, v21
    v_max3_u32 v15, v15, v22, v23
    v_cmp_eq_u32 vcc, -1, v15
    s_cbranch_vccz L_Gd
    s_sub_u32 s32, s32, 1
    s_cbranch_scc1 L_exit
    s_mov_b64 exec, vcc
    s_branch L_Gp
L_Gd:
    s_nop 1
    v_pk_add_f32 v[24:25], v[24:25], v[26:27]
    s_nop 1
    v_permlane32_swap_b32 v24, v25
    v_add_f32 v24, v24, v25
    v_mov_b32 v25, v24
    s_nop 1
    v_permlane16_swap_b32 v24, v25
    v_add_f32 v24, v24, v25
    v_cvt_pk_bf16_f32 v24, v24, v24
    s_mov_b32 exec_lo, 0xff
    s_mov_b32 exec_hi, 0xff
    buffer_store_short v24, v245, s[44:47], s101 offen
    s_branch L_exit
L_Eu:
    s_xor_b32 s48, s31, 1
    s_or_b32 s48, s48, s28
    s_or_b32 s48, s48, s62
    s_or_b32 s48, s48, s97
    s_cbranch_scc1 L_exit
    s_mov_b64 exec, 1
    v_mov_b32 v25, s96
    s_mov_b32 s48, 0x9000
    buffer_store_dword v25, v245, s[36:39], s48 offen sc1
L_exit:
L_end:
    s_endpgm
L_fin:
.section .rodata,"a"
.p2align 6
.amdhsa_kernel sequential_preLN__sliding_block_cached__swiglu_ffn__decode_kernel
  .amdhsa_next_free_vgpr 256
  .amdhsa_next_free_sgpr 102
  .amdhsa_accum_offset 256
  .amdhsa_group_segment_fixed_size 0
  .amdhsa_kernarg_size 96
  .amdhsa_user_sgpr_count 2
  .amdhsa_user_sgpr_kernarg_segment_ptr 1
  .amdhsa_system_sgpr_workgroup_id_x 1
  .amdhsa_float_denorm_mode_32 3
.end_amdhsa_kernel
```
